```python
import torch

def _softmax(x, axis=-1):
    return torch.softmax(x, dim=axis)
def _gelu(x):
    return torch.nn.functional.gelu(x, approximate="tanh")
def _silu(x):
    return torch.nn.functional.silu(x)
def _sigmoid(x):
    return torch.sigmoid(x)
def _layernorm(x, axis=-1, eps=1e-5):
    m = x.mean(dim=axis, keepdim=True)
    v = x.var(dim=axis, keepdim=True, unbiased=False)
    return (x - m) / torch.sqrt(v + eps)
def _scatter_add(tgt, idx, src, axis=0):
    return tgt.clone().index_add_(axis, idx, src)
def _segment_sum(src, seg, n):
    out = torch.zeros((n,) + src.shape[1:], dtype=src.dtype)
    return out.index_add_(0, seg, src)
def _pad(x, pw):
    flat = tuple(v for pair in reversed(pw) for v in pair)
    return torch.nn.functional.pad(x, flat)

kernel_name = 'standalone__edge_featured_mpnn_gatedgcn__graph'

def setup_inputs():

    _w = (lambda a: (lambda t: t.to(torch.bfloat16) if t.is_floating_point() else t)(torch.as_tensor(a)))
    N, deg, D, De = 25000, 16, 128, max(4, 1)
    E = N * deg
    return {
        "x": _w((lambda *s: torch.randn(*s, dtype=torch.bfloat16) * 0.4)(N, D)),
        "e_attr": _w((lambda *s: torch.randn(*s, dtype=torch.bfloat16) * 0.8)(E, De)),
        "src": _w((lambda lo, hi, *s: torch.randint(lo, hi, s))(0, N, E).to(torch.int64)),
        "dst": _w((lambda lo, hi, *s: torch.randint(lo, hi, s))(0, N, E).to(torch.int64)),
        "w_a": _w((lambda *s: torch.randn(*s, dtype=torch.bfloat16) * 0.4)(D, D)),
        "w_b": _w((lambda *s: torch.randn(*s, dtype=torch.bfloat16) * 0.4)(D, D)),
        "w_c": _w((lambda *s: torch.randn(*s, dtype=torch.bfloat16) * 0.8)(De, D)),
        "w_u": _w((lambda *s: torch.randn(*s, dtype=torch.bfloat16) * 0.05)(D, D)),
        "w_v": _w((lambda *s: torch.randn(*s, dtype=torch.bfloat16) * 0.05)(D, D)),
    }

def reference(x, e_attr, src, dst, w_a, w_b, w_c, w_u, w_v):
    N, D = x.shape
    hv = x @ w_v
    g = x[dst] @ w_a + x[src] @ w_b + e_attr @ w_c
    eta = _sigmoid(g)
    denom = _segment_sum(eta, dst, N) + 1e-6
    eta_n = eta / denom[dst]
    agg = _segment_sum(eta_n * hv[src], dst, N)
    z = x @ w_u + agg
    relu_z = torch.where(z > 0, z, 0 * z)
    return x + relu_z
```

```asm
; @launch grid=(256,1,1) block=(1024,1,1) lds=163840
.amdgcn_target "amdgcn-amd-amdhsa--gfx950"
.text
.globl standalone__edge_featured_mpnn_gatedgcn__graph_kernel
.p2align 8
.type standalone__edge_featured_mpnn_gatedgcn__graph_kernel,@function
standalone__edge_featured_mpnn_gatedgcn__graph_kernel:
    s_cmp_ge_u32 s2, 256
    s_cbranch_scc1 L_end
    s_load_dwordx16 s[16:31], s[0:1], 0
    s_load_dwordx8 s[32:39], s[0:1], 64
    v_lshrrev_b32 v2, 6, v0
    v_and_b32 v1, 63, v0
    v_lshlrev_b32 v4, 4, v0
    v_readfirstlane_b32 s3, v2
    v_mov_b32 v3, 0
    s_lshl_b32 s9, s2, 4
    s_add_u32 s9, s9, s3
    s_cmp_lg_u32 s9, 14
    s_cbranch_scc1 L_i0
    s_memrealtime s[12:13]
    s_waitcnt lgkmcnt(0)
    s_mul_i32 s14, s12, 0x9E3779B1
    s_mul_i32 s12, s12, 0x85EBCA6B
    s_xor_b32 s13, s13, s12
    s_bitset1_b32 s13, 31
    v_mov_b32 v8, s14
    v_mov_b32 v9, s13
    s_mov_b64 exec, 1
    global_store_dwordx2 v3, v[8:9], s[36:37] offset:136 sc1
    s_mov_b64 exec, -1
L_i0:
    v_lshrrev_b32 v6, 3, v0
    v_mul_u32_u24 v6, 384, v6
    v_and_b32 v7, 7, v0
    v_lshl_add_u32 v6, v7, 4, v6
    v_add_u32 v6, 137472, v6
    v_subrev_u32 v7, 8192, v4
    s_cmp_lt_u32 s3, 8
    s_cselect_b32 s9, 0x800007fc, 0
    v_mov_b32 v20, s9
    v_mov_b32 v21, s9
    v_mov_b32 v22, s9
    v_mov_b32 v23, s9
    s_cbranch_scc1 L_i1
    v_mov_b32 v6, v7
L_i1:
    s_cmp_ge_u32 s3, 12
    s_cbranch_scc1 L_i2
    ds_write_b128 v6, v[20:23]
L_i2:
    s_and_b32 s4, s2, 3
    s_lshr_b32 s5, s2, 3
    s_bfe_u32 s6, s2, 0x10002
    s_lshl_b32 s6, s6, 5
    s_add_u32 s5, s5, s6
    v_subrev_u32 v3, 5120, v4
    v_lshlrev_b32 v4, 1, v3
    s_mul_i32 s6, s2, 6256
    s_lshl_b32 s7, s6, 1
    s_movk_i32 s8, 6256
    s_cmp_eq_u32 s2, 255
    s_cselect_b32 s8, 4720, s8
    v_cmp_gt_u32 s[10:11], s8, v3
    v_lshrrev_b32 v5, 2, v1
    v_and_b32 v6, 3, v1
    v_lshlrev_b32 v6, 4, v6
    v_lshl_or_b32 v5, v5, 8, v6
    v_lshrrev_b32 v6, 4, v1
    v_and_b32 v7, 15, v1
    v_xor_b32 v16, v7, v6
    v_lshlrev_b32 v6, 8, v6
    v_lshl_or_b32 v16, v16, 4, v6
    v_mov_b32 v2, 1
    v_mov_b32 v30, 768
    s_cmp_lt_u32 s3, 5
    s_cbranch_scc1 L_i3
    s_setprio 2
L_i3:
    s_waitcnt lgkmcnt(0)
    s_barrier
    s_mov_b32 s40, s16
    s_mov_b32 s41, s17
    s_mov_b32 s42, 0x61a800
    s_mov_b32 s43, 0x20000
    s_cmp_ge_u32 s3, 5
    s_cbranch_scc1 L_l0
    s_cmp_eq_u32 s3, 4
    s_cbranch_scc1 L_e1
    s_cmp_eq_u32 s3, 0
    s_cselect_b64 s[12:13], s[26:27], s[32:33]
    s_cmp_eq_u32 s3, 2
    s_cselect_b64 s[12:13], s[24:25], s[12:13]
    s_cmp_eq_u32 s3, 3
    s_cselect_b64 s[12:13], s[30:31], s[12:13]
    s_mov_b32 s56, s12
    s_mov_b32 s57, s13
    s_mov_b32 s58, 0x8000
    s_mov_b32 s59, 0x20000
    s_lshl_b32 s15, s3, 13
    s_lshl_b32 s14, s4, 6
    s_add_u32 m0, s15, 104448
    s_add_u32 s12, s14, 0
    buffer_load_dwordx4 v5, s[56:59], s12 offen offset:0 lds
    s_add_u32 s12, s14, 3072
    buffer_load_dwordx4 v5, s[56:59], s12 offen offset:1024 lds
    s_add_u32 s12, s14, 6144
    buffer_load_dwordx4 v5, s[56:59], s12 offen offset:2048 lds
    s_add_u32 s12, s14, 9216
    buffer_load_dwordx4 v5, s[56:59], s12 offen offset:3072 lds
    s_add_u32 m0, s15, 108544
    s_add_u32 s12, s14, 16384
    buffer_load_dwordx4 v5, s[56:59], s12 offen offset:0 lds
    s_add_u32 s12, s14, 19456
    buffer_load_dwordx4 v5, s[56:59], s12 offen offset:1024 lds
    s_add_u32 s12, s14, 22528
    buffer_load_dwordx4 v5, s[56:59], s12 offen offset:2048 lds
    s_add_u32 s12, s14, 25600
    buffer_load_dwordx4 v5, s[56:59], s12 offen offset:3072 lds
L_e1:
    s_mov_b32 s52, s22
    s_mov_b32 s53, s23
    s_mov_b32 s54, 0x186a00
    s_mov_b32 s55, 0x20000
    s_mov_b32 s48, s20
    s_mov_b32 s49, s21
    s_mov_b32 s50, 0x186a00
    s_mov_b32 s51, 0x20000
    s_mov_b32 s44, s18
    s_mov_b32 s45, s19
    s_mov_b32 s46, 0x30d400
    s_mov_b32 s47, 0x20000
    s_mov_b32 s80, s28
    s_mov_b32 s81, s29
    s_mov_b32 s82, 0x400
    s_mov_b32 s83, 0x20000
    s_mov_b32 s60, s34
    s_mov_b32 s61, s35
    s_mov_b32 s62, 0x61a800
    s_mov_b32 s63, 0x20000
    s_mov_b32 s64, s36
    s_mov_b32 s65, s37
    s_mov_b32 s66, 0x100
    s_mov_b32 s67, 0x20000
    s_mov_b32 s68, s38
    s_mov_b32 s69, s39
    s_mov_b32 s70, 0x1000000
    s_mov_b32 s71, 0x20000
    s_mul_i32 s9, s4, 3276800
    s_add_u32 s9, s9, 16777216
    s_add_u32 s12, s38, s9
    s_addc_u32 s13, s39, 0
    s_mov_b32 s72, s12
    s_mov_b32 s73, s13
    s_mov_b32 s74, 0x320000
    s_mov_b32 s75, 0x20000
    s_mov_b32 s76, s12
    s_or_b32 s77, s13, 0x800000
    s_mov_b32 s78, 0x6400
    s_mov_b32 s79, 0x20000
    s_cmp_lt_u32 s3, 3
    s_cbranch_scc1 L_e3
    s_mov_b64 exec, 1
    s_waitcnt vmcnt(0)
    ds_add_u32 v30, v2 offset:28
    s_mov_b64 exec, -1
    s_mov_b32 s19, 2
    s_branch L_xg
L_e3:
    s_mul_i32 s14, s5, 100352
    s_lshl_b32 s15, s3, 13
    s_add_u32 s14, s14, s15
    s_add_u32 m0, s15, 4096
    v_xor_b32 v17, 64, v16
    v_xor_b32 v18, 0x80, v16
    v_xor_b32 v19, 0xc0, v16
    s_cmp_eq_u32 s3, 12
    buffer_load_dwordx4 v16, s[40:43], s14 offen lds
    buffer_load_dwordx4 v17, s[40:43], s14 offen offset:1024 lds
    s_cbranch_scc1 L_nx1
    buffer_load_dwordx4 v18, s[40:43], s14 offen offset:2048 lds
    buffer_load_dwordx4 v19, s[40:43], s14 offen offset:3072 lds
    s_add_u32 m0, s15, 8192
    s_add_u32 s14, s14, 4096
    buffer_load_dwordx4 v16, s[40:43], s14 offen lds
    buffer_load_dwordx4 v17, s[40:43], s14 offen offset:1024 lds
    buffer_load_dwordx4 v18, s[40:43], s14 offen offset:2048 lds
    buffer_load_dwordx4 v19, s[40:43], s14 offen offset:3072 lds
L_nx1:
    s_mov_b64 exec, 1
    s_waitcnt vmcnt(8)
    ds_add_u32 v30, v2 offset:28
    s_mov_b64 exec, -1
    s_branch L_g
L_l0:
    s_cmp_ge_u32 s3, 13
    s_cbranch_scc1 L_h0
    s_mov_b32 s52, s22
    s_mov_b32 s53, s23
    s_mov_b32 s54, 0x186a00
    s_mov_b32 s55, 0x20000
    s_mov_b32 s48, s20
    s_mov_b32 s49, s21
    s_mov_b32 s50, 0x186a00
    s_mov_b32 s51, 0x20000
    s_mov_b32 s44, s18
    s_mov_b32 s45, s19
    s_mov_b32 s46, 0x30d400
    s_mov_b32 s47, 0x20000
    s_cmp_eq_u64 s[10:11], 0
    s_cbranch_scc1 L_noedge
    s_mov_b64 exec, s[10:11]
    buffer_load_dwordx4 v[8:11], v3, s[52:55], s6 offen
    buffer_load_dwordx4 v[40:43], v3, s[48:51], s6 offen
    buffer_load_dwordx4 v[32:35], v4, s[44:47], s7 offen
    buffer_load_dwordx4 v[36:39], v4, s[44:47], s7 offen offset:16
    s_mov_b64 exec, -1
L_noedge:
    s_mov_b32 s80, s28
    s_mov_b32 s81, s29
    s_mov_b32 s82, 0x400
    s_mov_b32 s83, 0x20000
    s_mov_b32 s60, s34
    s_mov_b32 s61, s35
    s_mov_b32 s62, 0x61a800
    s_mov_b32 s63, 0x20000
    s_mov_b32 s64, s36
    s_mov_b32 s65, s37
    s_mov_b32 s66, 0x100
    s_mov_b32 s67, 0x20000
    s_mov_b32 s68, s38
    s_mov_b32 s69, s39
    s_mov_b32 s70, 0x1000000
    s_mov_b32 s71, 0x20000
    s_mul_i32 s9, s4, 3276800
    s_add_u32 s9, s9, 16777216
    s_add_u32 s12, s38, s9
    s_addc_u32 s13, s39, 0
    s_mov_b32 s72, s12
    s_mov_b32 s73, s13
    s_mov_b32 s74, 0x320000
    s_mov_b32 s75, 0x20000
    s_mov_b32 s76, s12
    s_or_b32 s77, s13, 0x800000
    s_mov_b32 s78, 0x6400
    s_mov_b32 s79, 0x20000
    s_cmp_eq_u64 s[10:11], 0
    s_cbranch_scc1 L_p_done
    s_mov_b64 exec, s[10:11]
    s_mov_b32 s16, 42800
    s_mov_b32 s17, 0x7ffff804
    s_movk_i32 s18, 384
    v_mov_b32 v3, 137216
    s_waitcnt vmcnt(3)
    v_mul_u32_u24 v44, s16, v8
    v_mul_u32_u24 v45, s16, v9
    v_mul_u32_u24 v46, s16, v10
    v_mul_u32_u24 v47, s16, v11
    v_lshrrev_b32 v44, 24, v44
    v_lshrrev_b32 v45, 24, v45
    v_lshrrev_b32 v46, 24, v46
    v_lshrrev_b32 v47, 24, v47
    v_lshlrev_b32 v48, 2, v44
    ds_add_rtn_u32 v20, v48, v2 offset:0
    v_lshlrev_b32 v49, 2, v45
    ds_add_rtn_u32 v21, v49, v2 offset:0
    v_lshlrev_b32 v50, 2, v46
    ds_add_rtn_u32 v22, v50, v2 offset:0
    v_lshlrev_b32 v51, 2, v47
    ds_add_rtn_u32 v23, v51, v2 offset:0
    v_mul_u32_u24 v48, 1568, v44
    v_lshl_add_u32 v8, v8, 2, s17
    v_sub_u32 v8, v8, v48
    v_mad_u32_u24 v48, v44, s18, v3
    v_mul_u32_u24 v49, 1568, v45
    v_lshl_add_u32 v9, v9, 2, s17
    v_sub_u32 v9, v9, v49
    v_mad_u32_u24 v49, v45, s18, v3
    v_mul_u32_u24 v50, 1568, v46
    v_lshl_add_u32 v10, v10, 2, s17
    v_sub_u32 v10, v10, v50
    v_mad_u32_u24 v50, v46, s18, v3
    v_mul_u32_u24 v51, 1568, v47
    v_lshl_add_u32 v11, v11, 2, s17
    v_sub_u32 v11, v11, v51
    v_mad_u32_u24 v51, v47, s18, v3
    s_waitcnt vmcnt(2)
    v_lshl_add_u32 v8, v40, 16, v8
    v_lshl_add_u32 v9, v41, 16, v9
    v_lshl_add_u32 v10, v42, 16, v10
    v_lshl_add_u32 v11, v43, 16, v11
    s_waitcnt lgkmcnt(3)
    v_add_u32 v52, v20, v44
    v_cmp_gt_u32 s[12:13], 32, v20
    v_and_b32 v52, 31, v52
    v_lshl_add_u32 v52, v52, 2, v48
    s_waitcnt lgkmcnt(2)
    v_add_u32 v53, v21, v45
    v_cmp_gt_u32 s[14:15], 32, v21
    v_and_b32 v53, 31, v53
    v_lshl_add_u32 v53, v53, 2, v49
    s_waitcnt lgkmcnt(1)
    v_add_u32 v54, v22, v46
    v_cmp_gt_u32 s[20:21], 32, v22
    v_and_b32 v54, 31, v54
    v_lshl_add_u32 v54, v54, 2, v50
    s_waitcnt lgkmcnt(0)
    v_add_u32 v55, v23, v47
    v_cmp_gt_u32 s[22:23], 32, v23
    v_and_b32 v55, 31, v55
    v_lshl_add_u32 v55, v55, 2, v51
    s_mov_b64 exec, s[12:13]
    ds_add_u32 v52, v8 offset:256
    s_mov_b64 exec, s[14:15]
    ds_add_u32 v53, v9 offset:256
    s_mov_b64 exec, s[20:21]
    ds_add_u32 v54, v10 offset:256
    s_mov_b64 exec, s[22:23]
    ds_add_u32 v55, v11 offset:256
    s_waitcnt vmcnt(1)
    s_mov_b64 exec, s[12:13]
    ds_write2_b32 v52, v32, v33 offset0:0 offset1:32
    s_mov_b64 exec, s[14:15]
    ds_write2_b32 v53, v34, v35 offset0:0 offset1:32
    s_waitcnt vmcnt(0)
    s_mov_b64 exec, s[20:21]
    ds_write2_b32 v54, v36, v37 offset0:0 offset1:32
    s_mov_b64 exec, s[22:23]
    ds_write2_b32 v55, v38, v39 offset0:0 offset1:32
    s_andn2_b64 exec, s[10:11], s[12:13]
    s_cbranch_execz L_po0
    ds_add_rtn_u32 v28, v30, v2 offset:8
    v_mov_b32 v24, v32
    v_mov_b32 v25, v33
    v_add_u32 v26, 0x800007fc, v8
    v_lshlrev_b32 v27, 9, v44
    v_lshl_add_u32 v27, v20, 4, v27
    v_mov_b32 v29, 0x800
    s_waitcnt lgkmcnt(0)
    v_max_u32 v31, v28, v20
    v_cmp_lt_u32 vcc, 62, v31
    v_lshlrev_b32 v28, 4, v28
    v_add_u32 v28, 161792, v28
    s_andn2_b64 s[24:25], exec, vcc
    s_mov_b64 exec, vcc
    ds_or_b32 v30, v2
    s_mov_b64 exec, s[24:25]
    ds_add_u32 v48, v29 offset:256
    ds_write_b128 v28, v[24:27]
L_po0:
    s_andn2_b64 exec, s[10:11], s[14:15]
    s_cbranch_execz L_po1
    ds_add_rtn_u32 v28, v30, v2 offset:8
    v_mov_b32 v24, v34
    v_mov_b32 v25, v35
    v_add_u32 v26, 0x800007fc, v9
    v_lshlrev_b32 v27, 9, v45
    v_lshl_add_u32 v27, v21, 4, v27
    v_mov_b32 v29, 0x800
    s_waitcnt lgkmcnt(0)
    v_max_u32 v31, v28, v21
    v_cmp_lt_u32 vcc, 62, v31
    v_lshlrev_b32 v28, 4, v28
    v_add_u32 v28, 161792, v28
    s_andn2_b64 s[24:25], exec, vcc
    s_mov_b64 exec, vcc
    ds_or_b32 v30, v2
    s_mov_b64 exec, s[24:25]
    ds_add_u32 v49, v29 offset:256
    ds_write_b128 v28, v[24:27]
L_po1:
    s_andn2_b64 exec, s[10:11], s[20:21]
    s_cbranch_execz L_po2
    ds_add_rtn_u32 v28, v30, v2 offset:8
    v_mov_b32 v24, v36
    v_mov_b32 v25, v37
    v_add_u32 v26, 0x800007fc, v10
    v_lshlrev_b32 v27, 9, v46
    v_lshl_add_u32 v27, v22, 4, v27
    v_mov_b32 v29, 0x800
    s_waitcnt lgkmcnt(0)
    v_max_u32 v31, v28, v22
    v_cmp_lt_u32 vcc, 62, v31
    v_lshlrev_b32 v28, 4, v28
    v_add_u32 v28, 161792, v28
    s_andn2_b64 s[24:25], exec, vcc
    s_mov_b64 exec, vcc
    ds_or_b32 v30, v2
    s_mov_b64 exec, s[24:25]
    ds_add_u32 v50, v29 offset:256
    ds_write_b128 v28, v[24:27]
L_po2:
    s_andn2_b64 exec, s[10:11], s[22:23]
    s_cbranch_execz L_po3
    ds_add_rtn_u32 v28, v30, v2 offset:8
    v_mov_b32 v24, v38
    v_mov_b32 v25, v39
    v_add_u32 v26, 0x800007fc, v11
    v_lshlrev_b32 v27, 9, v47
    v_lshl_add_u32 v27, v23, 4, v27
    v_mov_b32 v29, 0x800
    s_waitcnt lgkmcnt(0)
    v_max_u32 v31, v28, v23
    v_cmp_lt_u32 vcc, 62, v31
    v_lshlrev_b32 v28, 4, v28
    v_add_u32 v28, 161792, v28
    s_andn2_b64 s[24:25], exec, vcc
    s_mov_b64 exec, vcc
    ds_or_b32 v30, v2
    s_mov_b64 exec, s[24:25]
    ds_add_u32 v51, v29 offset:256
    ds_write_b128 v28, v[24:27]
L_po3:
L_p_done:
    s_mov_b64 exec, 1
    ds_add_u32 v30, v2 offset:4
    s_mov_b64 exec, -1
    s_setprio 0
    s_cmp_lt_u32 s3, 7
    s_cselect_b32 s19, 2, 3
L_xg:
    ds_read_b32 v32, v30 offset:16
    s_waitcnt lgkmcnt(0)
    v_readfirstlane_b32 s18, v32
    s_cmp_ge_u32 s18, s19
    s_cbranch_scc1 L_xgd
    s_sleep 1
    s_branch L_xg
L_xgd:
    s_mul_i32 s14, s5, 100352
    s_lshl_b32 s15, s3, 13
    s_add_u32 s14, s14, s15
    s_add_u32 m0, s15, 4096
    v_xor_b32 v17, 64, v16
    v_xor_b32 v18, 0x80, v16
    v_xor_b32 v19, 0xc0, v16
    s_cmp_eq_u32 s3, 12
    buffer_load_dwordx4 v16, s[40:43], s14 offen lds
    buffer_load_dwordx4 v17, s[40:43], s14 offen offset:1024 lds
    s_cbranch_scc1 L_nx2
    buffer_load_dwordx4 v18, s[40:43], s14 offen offset:2048 lds
    buffer_load_dwordx4 v19, s[40:43], s14 offen offset:3072 lds
    s_add_u32 m0, s15, 8192
    s_add_u32 s14, s14, 4096
    buffer_load_dwordx4 v16, s[40:43], s14 offen lds
    buffer_load_dwordx4 v17, s[40:43], s14 offen offset:1024 lds
    buffer_load_dwordx4 v18, s[40:43], s14 offen offset:2048 lds
    buffer_load_dwordx4 v19, s[40:43], s14 offen offset:3072 lds
L_nx2:
    s_branch L_g
L_h0:
    s_mov_b32 s52, s22
    s_mov_b32 s53, s23
    s_mov_b32 s54, 0x186a00
    s_mov_b32 s55, 0x20000
    s_mov_b32 s48, s20
    s_mov_b32 s49, s21
    s_mov_b32 s50, 0x186a00
    s_mov_b32 s51, 0x20000
    s_mov_b32 s44, s18
    s_mov_b32 s45, s19
    s_mov_b32 s46, 0x30d400
    s_mov_b32 s47, 0x20000
    s_mov_b32 s80, s28
    s_mov_b32 s81, s29
    s_mov_b32 s82, 0x400
    s_mov_b32 s83, 0x20000
    s_mov_b32 s60, s34
    s_mov_b32 s61, s35
    s_mov_b32 s62, 0x61a800
    s_mov_b32 s63, 0x20000
    s_mov_b32 s64, s36
    s_mov_b32 s65, s37
    s_mov_b32 s66, 0x100
    s_mov_b32 s67, 0x20000
    s_mov_b32 s68, s38
    s_mov_b32 s69, s39
    s_mov_b32 s70, 0x1000000
    s_mov_b32 s71, 0x20000
    s_mul_i32 s9, s4, 3276800
    s_add_u32 s9, s9, 16777216
    s_add_u32 s12, s38, s9
    s_addc_u32 s13, s39, 0
    s_mov_b32 s72, s12
    s_mov_b32 s73, s13
    s_mov_b32 s74, 0x320000
    s_mov_b32 s75, 0x20000
    s_mov_b32 s76, s12
    s_or_b32 s77, s13, 0x800000
    s_mov_b32 s78, 0x6400
    s_mov_b32 s79, 0x20000
    v_lshlrev_b32 v4, 4, v1
    s_mul_i32 s16, s2, 24576
    v_mov_b32 v3, 0
    s_movk_i32 s17, 384
    s_cmp_eq_u32 s3, 13
    s_cbranch_scc1 L_h13
    v_lshrrev_b32 v8, 4, v1
    v_lshlrev_b32 v9, 4, v7
    v_mad_u32_u24 v8, v8, s17, v9
    s_cmp_lg_u32 s3, 15
    s_cbranch_scc1 L_h2
    v_add_u32 v8, 12288, v8
    v_lshl_or_b32 v6, v7, 2, v6
    s_movk_i32 m0, 3712
    s_lshl_b32 s9, s4, 6
    buffer_load_dword v6, s[80:83], s9 offen lds
L_h2:
    v_add_u32 v9, 137216, v8
    s_add_u32 s17, s16, 4608
    s_add_u32 s19, s16, 9216
    s_setprio 0
L_hp:
    ds_read_b32 v32, v30 offset:4
    s_waitcnt lgkmcnt(0)
    v_readfirstlane_b32 s18, v32
    s_cmp_ge_u32 s18, 8
    s_cbranch_scc1 L_hpd
    s_sleep 1
    s_branch L_hp
L_hpd:
    s_setprio 3
    ds_read_b128 v[64:67], v9 offset:0
    ds_read_b128 v[68:71], v9 offset:1536
    ds_read_b128 v[72:75], v9 offset:3072
    ds_read_b128 v[76:79], v9 offset:4608
    ds_read_b128 v[80:83], v9 offset:6144
    ds_read_b128 v[84:87], v9 offset:7680
    ds_read_b128 v[88:91], v9 offset:9216
    ds_read_b128 v[92:95], v9 offset:10752
    s_waitcnt lgkmcnt(7)
    buffer_store_dwordx4 v[64:67], v8, s[68:71], s16 offen offset:0 sc1
    s_waitcnt lgkmcnt(6)
    buffer_store_dwordx4 v[68:71], v8, s[68:71], s16 offen offset:1536 sc1
    s_waitcnt lgkmcnt(5)
    buffer_store_dwordx4 v[72:75], v8, s[68:71], s16 offen offset:3072 sc1
    s_waitcnt lgkmcnt(4)
    buffer_store_dwordx4 v[76:79], v8, s[68:71], s17 offen offset:0 sc1
    s_waitcnt lgkmcnt(3)
    buffer_store_dwordx4 v[80:83], v8, s[68:71], s17 offen offset:1536 sc1
    s_waitcnt lgkmcnt(2)
    buffer_store_dwordx4 v[84:87], v8, s[68:71], s17 offen offset:3072 sc1
    s_waitcnt lgkmcnt(1)
    buffer_store_dwordx4 v[88:91], v8, s[68:71], s19 offen offset:0 sc1
    s_waitcnt lgkmcnt(0)
    buffer_store_dwordx4 v[92:95], v8, s[68:71], s19 offen offset:1536 sc1
    s_mov_b64 exec, 1
    ds_add_u32 v30, v2 offset:16
    s_waitcnt vmcnt(0)
    ds_add_u32 v30, v2 offset:20
    s_branch L_pso
L_h13:
    v_lshrrev_b32 v8, 3, v1
    v_and_b32 v9, 0x70, v4
    v_mad_u32_u24 v8, v8, s17, v9
    v_add_u32 v9, 137472, v8
    v_add_u32 v5, 161792, v4
    s_mov_b32 s18, 0x40000
L_tag:
    buffer_load_dwordx2 v[46:47], v3, s[64:67], 0 offen offset:136 sc1
    s_waitcnt vmcnt(0)
    v_cmp_eq_u32 vcc, 0, v47
    s_sub_u32 s18, s18, 1
    s_cbranch_scc1 L_tagd
    s_cbranch_vccz L_tagd
    s_sleep 1
    s_branch L_tag
L_tagd:
    v_or_b32 v47, 0x80000000, v47
    ds_write_b64 v30, v[46:47] offset:40
    v_and_b32 v45, 7, v1
    v_cmp_eq_u32 vcc, 0, v45
    v_lshlrev_b32 v45, 2, v45
    v_lshrrev_b64 v[46:47], v45, v[46:47]
    v_mov_b32 v44, 0xf803
    v_cndmask_b32 v44, v44, 2, vcc
    v_and_b32 v40, v44, v46
    v_lshrrev_b32 v41, 5, v46
    v_lshrrev_b32 v42, 10, v46
    v_lshrrev_b32 v43, 15, v46
    v_and_b32 v41, 0xf803, v41
    v_and_b32 v42, 0xf803, v42
    v_and_b32 v43, 0xf803, v43
    s_setprio 0
L_hq:
    ds_read_b32 v32, v30 offset:4
    s_waitcnt lgkmcnt(0)
    v_readfirstlane_b32 s18, v32
    s_cmp_ge_u32 s18, 8
    s_cbranch_scc1 L_hqd
    s_sleep 1
    s_branch L_hq
L_hqd:
    s_setprio 3
    ds_read_b96 v[36:38], v30
    ds_read_b128 v[24:27], v5
    ds_read_b128 v[64:67], v9 offset:0
    ds_read_b128 v[68:71], v9 offset:3072
    ds_read_b128 v[72:75], v9 offset:6144
    ds_read_b128 v[76:79], v9 offset:9216
    ds_read_b128 v[80:83], v9 offset:12288
    ds_read_b128 v[84:87], v9 offset:15360
    ds_read_b128 v[88:91], v9 offset:18432
    ds_read_b128 v[92:95], v9 offset:21504
    s_lshl_b32 s19, s2, 15
    s_add_u32 s19, s19, 8388096
    s_waitcnt lgkmcnt(8)
    v_cmp_gt_u32 s[20:21], v38, v1
    v_cmp_eq_u32 vcc, 0, v36
    v_and_b32 v36, 1, v36
    v_bfi_b32 v36, v44, 0, v36
    v_or_b32 v40, v40, v36
    s_and_b64 exec, s[20:21], vcc
    s_cbranch_scc0 L_psn
    buffer_store_dwordx4 v[24:27], v27, s[68:71], s19 offen sc1
L_psn:
    s_mov_b64 exec, 1
    ds_add_u32 v30, v2 offset:48
    s_mov_b64 exec, -1
    s_waitcnt lgkmcnt(8)
    v_xor_b32 v64, v64, v40
    v_xor_b32 v65, v65, v41
    v_xor_b32 v66, v66, v42
    v_xor_b32 v67, v67, v43
    s_waitcnt lgkmcnt(7)
    v_xor_b32 v68, v68, v40
    v_xor_b32 v69, v69, v41
    v_xor_b32 v70, v70, v42
    v_xor_b32 v71, v71, v43
    s_waitcnt lgkmcnt(6)
    v_xor_b32 v72, v72, v40
    v_xor_b32 v73, v73, v41
    v_xor_b32 v74, v74, v42
    v_xor_b32 v75, v75, v43
    s_waitcnt lgkmcnt(5)
    v_xor_b32 v76, v76, v40
    v_xor_b32 v77, v77, v41
    v_xor_b32 v78, v78, v42
    v_xor_b32 v79, v79, v43
    s_waitcnt lgkmcnt(4)
    v_xor_b32 v80, v80, v40
    v_xor_b32 v81, v81, v41
    v_xor_b32 v82, v82, v42
    v_xor_b32 v83, v83, v43
    s_waitcnt lgkmcnt(3)
    v_xor_b32 v84, v84, v40
    v_xor_b32 v85, v85, v41
    v_xor_b32 v86, v86, v42
    v_xor_b32 v87, v87, v43
    s_waitcnt lgkmcnt(2)
    v_xor_b32 v88, v88, v40
    v_xor_b32 v89, v89, v41
    v_xor_b32 v90, v90, v42
    v_xor_b32 v91, v91, v43
    s_waitcnt lgkmcnt(1)
    v_xor_b32 v92, v92, v40
    v_xor_b32 v93, v93, v41
    v_xor_b32 v94, v94, v42
    v_xor_b32 v95, v95, v43
    s_waitcnt vmcnt(0)
L_hr:
    ds_read_b32 v32, v30 offset:20
    s_waitcnt lgkmcnt(0)
    v_readfirstlane_b32 s18, v32
    s_cmp_ge_u32 s18, 2
    s_cbranch_scc1 L_hrd
    s_sleep 1
    s_branch L_hr
L_hrd:
    buffer_store_dwordx4 v[64:67], v8, s[68:71], s16 offen offset:256 sc1
    s_add_u32 s16, s16, 3072
    buffer_store_dwordx4 v[68:71], v8, s[68:71], s16 offen offset:256 sc1
    s_add_u32 s16, s16, 3072
    buffer_store_dwordx4 v[72:75], v8, s[68:71], s16 offen offset:256 sc1
    s_add_u32 s16, s16, 3072
    buffer_store_dwordx4 v[76:79], v8, s[68:71], s16 offen offset:256 sc1
    s_add_u32 s16, s16, 3072
    buffer_store_dwordx4 v[80:83], v8, s[68:71], s16 offen offset:256 sc1
    s_add_u32 s16, s16, 3072
    buffer_store_dwordx4 v[84:87], v8, s[68:71], s16 offen offset:256 sc1
    s_add_u32 s16, s16, 3072
    buffer_store_dwordx4 v[88:91], v8, s[68:71], s16 offen offset:256 sc1
    s_add_u32 s16, s16, 3072
    buffer_store_dwordx4 v[92:95], v8, s[68:71], s16 offen offset:256 sc1
    s_mov_b64 exec, 1
    ds_add_u32 v30, v2 offset:16
L_pso:
    s_sub_u32 s17, s3, 8
    s_branch L_sw
L_g:
    v_and_b32 v20, 31, v1
    v_lshrrev_b32 v21, 5, v1
    s_lshl_b32 s18, s3, 13
    s_add_u32 s18, s18, 4096
    v_and_b32 v22, 15, v1
    v_xor_b32 v22, v22, v21
    v_lshlrev_b32 v22, 4, v22
    v_lshl_or_b32 v22, v20, 8, v22
    v_add_u32 v4, s18, v22
    v_bfe_u32 v22, v1, 2, 2
    v_lshl_add_u32 v22, v21, 3, v22
    v_lshlrev_b32 v22, 6, v22
    v_and_b32 v23, 16, v1
    v_lshl_add_u32 v22, v23, 1, v22
    v_and_b32 v23, 3, v1
    v_lshl_add_u32 v22, v23, 3, v22
    v_add_u32 v5, 104448, v22
    v_bfe_u32 v22, v1, 1, 3
    v_xor_b32 v22, v22, v21
    v_lshlrev_b32 v22, 4, v22
    v_lshl_or_b32 v22, v20, 7, v22
    v_add_u32 v6, s18, v22
    v_lshl_add_u32 v7, v1, 4, s18
    v_and_b32 v22, 7, v1
    v_lshrrev_b32 v23, 4, v1
    v_xor_b32 v22, v22, v23
    v_lshlrev_b32 v22, 4, v22
    v_lshrrev_b32 v23, 3, v1
    v_lshl_or_b32 v8, v23, 7, v22
    v_xor_b32 v9, 64, v8
    v_mul_u32_u24 v22, 6288, v21
    v_lshl_add_u32 v22, v20, 4, v22
    s_lshl_b32 s18, s3, 9
    s_add_u32 s18, s18, 113536
    v_add_u32 v10, s18, v22
    v_xor_b32 v11, 32, v6
    v_xor_b32 v12, 64, v6
    v_xor_b32 v13, 0x60, v6
    s_mul_i32 s19, s5, 50176
    s_lshl_b32 s18, s3, 12
    s_add_u32 s19, s19, s18
    s_mov_b32 s20, 0xbfb8aa3b
    s_mov_b32 s21, 0xbfb8aa3b
    s_mov_b32 s22, 0x07060100
    s_mov_b32 s23, 0x07060302
    s_cmp_eq_u32 s3, 12
    s_cselect_b32 s26, 0xff, -1
    s_cselect_b32 s27, 0xff, -1
    v_xor_b32 v49, 0x20, v4
    v_xor_b32 v50, 0x40, v4
    v_xor_b32 v51, 0x60, v4
    v_xor_b32 v52, 0x80, v4
    v_xor_b32 v53, 0xa0, v4
    v_xor_b32 v54, 0xc0, v4
    v_xor_b32 v55, 0xe0, v4
L_wc:
    ds_read_b32 v32, v30 offset:28
    s_waitcnt lgkmcnt(0)
    v_readfirstlane_b32 s18, v32
    s_cmp_ge_u32 s18, 5
    s_cbranch_scc1 L_wcd
    s_sleep 1
    s_branch L_wc
L_wcd:
    ds_read_b64_tr_b16 v[112:113], v5 offset:0
    ds_read_b64_tr_b16 v[114:115], v5 offset:256
    ds_read_b64_tr_b16 v[116:117], v5 offset:8192
    ds_read_b64_tr_b16 v[118:119], v5 offset:8448
    ds_read_b64_tr_b16 v[120:121], v5 offset:1024
    ds_read_b64_tr_b16 v[122:123], v5 offset:1280
    ds_read_b64_tr_b16 v[124:125], v5 offset:9216
    ds_read_b64_tr_b16 v[126:127], v5 offset:9472
    s_waitcnt vmcnt(0) lgkmcnt(0)
    ds_read_b128 v[16:19], v4
    ds_read_b128 v[20:23], v49
    ds_read_b128 v[24:27], v50
    ds_read_b128 v[28:31], v51
    ds_read_b128 v[32:35], v52
    ds_read_b128 v[36:39], v53
    ds_read_b128 v[40:43], v54
    ds_read_b128 v[44:47], v55
    s_cmp_eq_u32 s3, 12
    s_waitcnt lgkmcnt(7)
    v_mfma_f32_32x32x16_bf16 v[48:63], v[112:115], v[16:19], 0
    ds_read_b64_tr_b16 v[112:113], v5 offset:2048
    ds_read_b64_tr_b16 v[114:115], v5 offset:2304
    v_mfma_f32_32x32x16_bf16 v[64:79], v[116:119], v[16:19], 0
    ds_read_b64_tr_b16 v[116:117], v5 offset:10240
    ds_read_b64_tr_b16 v[118:119], v5 offset:10496
    s_waitcnt lgkmcnt(10)
    v_mfma_f32_32x32x16_bf16 v[48:63], v[120:123], v[20:23], v[48:63]
    ds_read_b64_tr_b16 v[120:121], v5 offset:3072
    ds_read_b64_tr_b16 v[122:123], v5 offset:3328
    v_mfma_f32_32x32x16_bf16 v[64:79], v[124:127], v[20:23], v[64:79]
    ds_read_b64_tr_b16 v[124:125], v5 offset:11264
    ds_read_b64_tr_b16 v[126:127], v5 offset:11520
    s_waitcnt lgkmcnt(6)
    v_mfma_f32_32x32x16_bf16 v[48:63], v[112:115], v[24:27], v[48:63]
    ds_read_b64_tr_b16 v[112:113], v5 offset:4096
    ds_read_b64_tr_b16 v[114:115], v5 offset:4352
    s_waitcnt lgkmcnt(6)
    v_mfma_f32_32x32x16_bf16 v[64:79], v[116:119], v[24:27], v[64:79]
    ds_read_b64_tr_b16 v[116:117], v5 offset:12288
    ds_read_b64_tr_b16 v[118:119], v5 offset:12544
    s_waitcnt lgkmcnt(6)
    v_mfma_f32_32x32x16_bf16 v[48:63], v[120:123], v[28:31], v[48:63]
    ds_read_b64_tr_b16 v[120:121], v5 offset:5120
    ds_read_b64_tr_b16 v[122:123], v5 offset:5376
    s_waitcnt lgkmcnt(6)
    v_mfma_f32_32x32x16_bf16 v[64:79], v[124:127], v[28:31], v[64:79]
    ds_read_b64_tr_b16 v[124:125], v5 offset:13312
    ds_read_b64_tr_b16 v[126:127], v5 offset:13568
    s_waitcnt lgkmcnt(6)
    v_mfma_f32_32x32x16_bf16 v[48:63], v[112:115], v[32:35], v[48:63]
    ds_read_b64_tr_b16 v[112:113], v5 offset:6144
    ds_read_b64_tr_b16 v[114:115], v5 offset:6400
    s_waitcnt lgkmcnt(6)
    v_mfma_f32_32x32x16_bf16 v[64:79], v[116:119], v[32:35], v[64:79]
    ds_read_b64_tr_b16 v[116:117], v5 offset:14336
    ds_read_b64_tr_b16 v[118:119], v5 offset:14592
    s_waitcnt lgkmcnt(6)
    v_mfma_f32_32x32x16_bf16 v[48:63], v[120:123], v[36:39], v[48:63]
    ds_read_b64_tr_b16 v[120:121], v5 offset:7168
    ds_read_b64_tr_b16 v[122:123], v5 offset:7424
    s_waitcnt lgkmcnt(6)
    v_mfma_f32_32x32x16_bf16 v[64:79], v[124:127], v[36:39], v[64:79]
    ds_read_b64_tr_b16 v[124:125], v5 offset:15360
    ds_read_b64_tr_b16 v[126:127], v5 offset:15616
    s_waitcnt lgkmcnt(6)
    v_mfma_f32_32x32x16_bf16 v[48:63], v[112:115], v[40:43], v[48:63]
    ds_read_b64_tr_b16 v[112:113], v5 offset:16384
    ds_read_b64_tr_b16 v[114:115], v5 offset:16640
    s_waitcnt lgkmcnt(6)
    v_mfma_f32_32x32x16_bf16 v[64:79], v[116:119], v[40:43], v[64:79]
    ds_read_b64_tr_b16 v[116:117], v5 offset:24576
    ds_read_b64_tr_b16 v[118:119], v5 offset:24832
    s_waitcnt lgkmcnt(6)
    v_mfma_f32_32x32x16_bf16 v[48:63], v[120:123], v[44:47], v[48:63]
    ds_read_b64_tr_b16 v[120:121], v5 offset:17408
    ds_read_b64_tr_b16 v[122:123], v5 offset:17664
    s_waitcnt lgkmcnt(6)
    v_mfma_f32_32x32x16_bf16 v[64:79], v[124:127], v[44:47], v[64:79]
    ds_read_b64_tr_b16 v[124:125], v5 offset:25600
    ds_read_b64_tr_b16 v[126:127], v5 offset:25856
    s_waitcnt lgkmcnt(6)
    v_mfma_f32_32x32x16_bf16 v[80:95], v[112:115], v[16:19], 0
    ds_read_b64_tr_b16 v[112:113], v5 offset:18432
    ds_read_b64_tr_b16 v[114:115], v5 offset:18688
    s_waitcnt lgkmcnt(6)
    v_mfma_f32_32x32x16_bf16 v[96:111], v[116:119], v[16:19], 0
    ds_read_b64_tr_b16 v[116:117], v5 offset:26624
    ds_read_b64_tr_b16 v[118:119], v5 offset:26880
    s_waitcnt lgkmcnt(6)
    v_mfma_f32_32x32x16_bf16 v[80:95], v[120:123], v[20:23], v[80:95]
    ds_read_b64_tr_b16 v[120:121], v5 offset:19456
    ds_read_b64_tr_b16 v[122:123], v5 offset:19712
    v_pk_mul_f32 v[48:49], v[48:49], s[20:21]
    v_pk_mul_f32 v[50:51], v[50:51], s[20:21]
    v_cvt_pk_bf16_f32 v48, v48, v49
    v_cvt_pk_bf16_f32 v49, v50, v51
    v_perm_b32 v64, v64, v48, s22
    s_waitcnt lgkmcnt(6)
    v_mfma_f32_32x32x16_bf16 v[96:111], v[124:127], v[20:23], v[96:111]
    ds_read_b64_tr_b16 v[124:125], v5 offset:27648
    ds_read_b64_tr_b16 v[126:127], v5 offset:27904
    v_perm_b32 v65, v65, v48, s23
    v_perm_b32 v66, v66, v49, s22
    v_perm_b32 v67, v67, v49, s23
    s_mov_b64 exec, s[26:27]
    ds_write_b128 v6, v[64:67]
    s_mov_b64 exec, -1
    v_pk_mul_f32 v[52:53], v[52:53], s[20:21]
    s_waitcnt lgkmcnt(7)
    v_mfma_f32_32x32x16_bf16 v[80:95], v[112:115], v[24:27], v[80:95]
    ds_read_b64_tr_b16 v[112:113], v5 offset:20480
    ds_read_b64_tr_b16 v[114:115], v5 offset:20736
    v_pk_mul_f32 v[54:55], v[54:55], s[20:21]
    v_cvt_pk_bf16_f32 v52, v52, v53
    v_cvt_pk_bf16_f32 v53, v54, v55
    v_perm_b32 v68, v68, v52, s22
    v_perm_b32 v69, v69, v52, s23
    s_waitcnt lgkmcnt(7)
    v_mfma_f32_32x32x16_bf16 v[96:111], v[116:119], v[24:27], v[96:111]
    ds_read_b64_tr_b16 v[116:117], v5 offset:28672
    ds_read_b64_tr_b16 v[118:119], v5 offset:28928
    v_perm_b32 v70, v70, v53, s22
    v_perm_b32 v71, v71, v53, s23
    s_mov_b64 exec, s[26:27]
    ds_write_b128 v11, v[68:71]
    s_mov_b64 exec, -1
    v_pk_mul_f32 v[56:57], v[56:57], s[20:21]
    v_pk_mul_f32 v[58:59], v[58:59], s[20:21]
    s_waitcnt lgkmcnt(8)
    v_mfma_f32_32x32x16_bf16 v[80:95], v[120:123], v[28:31], v[80:95]
    ds_read_b64_tr_b16 v[120:121], v5 offset:21504
    ds_read_b64_tr_b16 v[122:123], v5 offset:21760
    v_cvt_pk_bf16_f32 v56, v56, v57
    v_cvt_pk_bf16_f32 v57, v58, v59
    v_perm_b32 v72, v72, v56, s22
    v_perm_b32 v73, v73, v56, s23
    v_perm_b32 v74, v74, v57, s22
    s_waitcnt lgkmcnt(8)
    v_mfma_f32_32x32x16_bf16 v[96:111], v[124:127], v[28:31], v[96:111]
    ds_read_b64_tr_b16 v[124:125], v5 offset:29696
    ds_read_b64_tr_b16 v[126:127], v5 offset:29952
    v_perm_b32 v75, v75, v57, s23
    s_mov_b64 exec, s[26:27]
    ds_write_b128 v12, v[72:75]
    s_mov_b64 exec, -1
    v_pk_mul_f32 v[60:61], v[60:61], s[20:21]
    v_pk_mul_f32 v[62:63], v[62:63], s[20:21]
    v_cvt_pk_bf16_f32 v60, v60, v61
    s_waitcnt lgkmcnt(8)
    v_mfma_f32_32x32x16_bf16 v[80:95], v[112:115], v[32:35], v[80:95]
    ds_read_b64_tr_b16 v[112:113], v5 offset:22528
    ds_read_b64_tr_b16 v[114:115], v5 offset:22784
    v_cvt_pk_bf16_f32 v61, v62, v63
    v_perm_b32 v76, v76, v60, s22
    v_perm_b32 v77, v77, v60, s23
    v_perm_b32 v78, v78, v61, s22
    v_perm_b32 v79, v79, v61, s23
    s_waitcnt lgkmcnt(8)
    v_mfma_f32_32x32x16_bf16 v[96:111], v[116:119], v[32:35], v[96:111]
    ds_read_b64_tr_b16 v[116:117], v5 offset:30720
    ds_read_b64_tr_b16 v[118:119], v5 offset:30976
    s_mov_b64 exec, s[26:27]
    ds_write_b128 v13, v[76:79]
    s_mov_b64 exec, -1
    ds_read_b128 v[48:51], v7 offset:0
    ds_read_b128 v[52:55], v7 offset:1024
    ds_read_b128 v[56:59], v7 offset:2048
    ds_read_b128 v[60:63], v7 offset:3072
    s_waitcnt lgkmcnt(12)
    v_mfma_f32_32x32x16_bf16 v[80:95], v[120:123], v[36:39], v[80:95]
    ds_read_b64_tr_b16 v[120:121], v5 offset:23552
    ds_read_b64_tr_b16 v[122:123], v5 offset:23808
    s_waitcnt lgkmcnt(5)
    buffer_store_dwordx4 v[48:51], v8, s[72:75], s19 offen offset:0 sc1
    v_mfma_f32_32x32x16_bf16 v[96:111], v[124:127], v[36:39], v[96:111]
    ds_read_b64_tr_b16 v[124:125], v5 offset:31744
    ds_read_b64_tr_b16 v[126:127], v5 offset:32000
    s_waitcnt lgkmcnt(6)
    s_cbranch_scc1 L_gs1
    buffer_store_dwordx4 v[52:55], v9, s[72:75], s19 offen offset:1024 sc1
L_gs1:
    v_mfma_f32_32x32x16_bf16 v[80:95], v[112:115], v[40:43], v[80:95]
    s_waitcnt lgkmcnt(5)
    s_cbranch_scc1 L_gs2
    buffer_store_dwordx4 v[56:59], v8, s[72:75], s19 offen offset:2048 sc1
L_gs2:
    v_mfma_f32_32x32x16_bf16 v[96:111], v[116:119], v[40:43], v[96:111]
    s_waitcnt lgkmcnt(4)
    s_cbranch_scc1 L_gs3
    buffer_store_dwordx4 v[60:63], v9, s[72:75], s19 offen offset:3072 sc1
L_gs3:
    s_waitcnt lgkmcnt(2)
    v_mfma_f32_32x32x16_bf16 v[80:95], v[120:123], v[44:47], v[80:95]
    s_waitcnt lgkmcnt(0)
    v_mfma_f32_32x32x16_bf16 v[96:111], v[124:127], v[44:47], v[96:111]
    s_cselect_b32 s18, s5, 0
    v_mov_b32 v32, 0x7180
    v_mov_b32 v33, 0x7180
    v_mov_b32 v34, 0x7180
    v_mov_b32 v35, 0x7180
    v_lshlrev_b32 v12, 4, v1
    s_cmp_lg_u32 s18, 63
    s_cbranch_scc1 L_nodum
    s_mov_b32 s18, 3212800
    buffer_store_dwordx4 v[32:35], v12, s[72:75], s18 offen sc1
    buffer_store_dwordx4 v[32:35], v12, s[72:75], s18 offen offset:1024 sc1
    buffer_store_dwordx4 v[32:35], v12, s[72:75], s18 offen offset:2048 sc1
    buffer_store_dwordx4 v[32:35], v12, s[72:75], s18 offen offset:3072 sc1
L_nodum:
    s_movk_i32 s18, 820
    s_cmp_lt_u32 s3, 5
    s_cselect_b32 s18, 792, s18
    s_cmp_lt_u32 s3, 9
    s_cselect_b32 s18, s18, 816
    v_mov_b32 v31, 1
    v_mov_b32 v30, s18
    s_mov_b64 exec, 1
    ds_add_u32 v30, v31
    s_mov_b64 exec, -1
    v_mov_b32 v30, 768
    v_pk_mul_f32 v[80:81], v[80:81], s[20:21]
    v_pk_mul_f32 v[82:83], v[82:83], s[20:21]
    v_cvt_pk_bf16_f32 v80, v80, v81
    v_cvt_pk_bf16_f32 v81, v82, v83
    v_perm_b32 v96, v96, v80, s22
    v_perm_b32 v97, v97, v80, s23
    v_perm_b32 v98, v98, v81, s22
    v_perm_b32 v99, v99, v81, s23
    v_pk_mul_f32 v[84:85], v[84:85], s[20:21]
    v_pk_mul_f32 v[86:87], v[86:87], s[20:21]
    v_cvt_pk_bf16_f32 v84, v84, v85
    v_cvt_pk_bf16_f32 v85, v86, v87
    v_perm_b32 v100, v100, v84, s22
    v_perm_b32 v101, v101, v84, s23
    v_perm_b32 v102, v102, v85, s22
    v_perm_b32 v103, v103, v85, s23
    v_pk_mul_f32 v[88:89], v[88:89], s[20:21]
    v_pk_mul_f32 v[90:91], v[90:91], s[20:21]
    v_cvt_pk_bf16_f32 v88, v88, v89
    v_cvt_pk_bf16_f32 v89, v90, v91
    v_perm_b32 v104, v104, v88, s22
    v_perm_b32 v105, v105, v88, s23
    v_perm_b32 v106, v106, v89, s22
    v_perm_b32 v107, v107, v89, s23
    v_pk_mul_f32 v[92:93], v[92:93], s[20:21]
    v_pk_mul_f32 v[94:95], v[94:95], s[20:21]
    v_cvt_pk_bf16_f32 v92, v92, v93
    v_cvt_pk_bf16_f32 v93, v94, v95
    v_perm_b32 v108, v108, v92, s22
    v_perm_b32 v109, v109, v92, s23
    v_perm_b32 v110, v110, v93, s22
    v_perm_b32 v111, v111, v93, s23
    s_mov_b32 s17, s3
    s_cmp_lt_u32 s3, 5
    s_cbranch_scc1 L_sw
    s_mov_b32 s16, 0
    s_sub_u32 s17, s3, 5
L_c1:
    ds_read_b32 v84, v30 offset:20
    s_waitcnt lgkmcnt(0)
    v_readfirstlane_b32 s18, v84
    s_cmp_ge_u32 s18, 2
    s_cbranch_scc1 L_c1d
    s_sleep 1
    s_branch L_c1
L_c1d:
    v_and_b32 v92, 7, v1
    v_lshrrev_b32 v93, 4, v1
    v_lshl_add_u32 v88, v92, 2, v93
    v_lshlrev_b32 v88, 1, v88
    ds_read_u16 v84, v88 offset:3712
    ds_read_u16 v85, v88 offset:3776
    ds_read_u16 v86, v88 offset:3840
    ds_read_u16 v87, v88 offset:3904
    v_bfe_u32 v94, v1, 2, 2
    v_and_b32 v95, 3, v1
    v_cmp_eq_u32 s[36:37], v93, v95
    v_mul_u32_u24 v122, 6288, v92
    v_add_u32 v122, 113536, v122
    s_mul_i32 s18, s5, 100352
    s_lshl_b32 s19, s4, 6
    s_add_u32 s18, s18, s19
    v_lshl_add_u32 v123, v92, 3, s18
    v_cmp_eq_u32 vcc, v94, v93
    v_mov_b32 v89, 0x3f80
    v_mov_b32 v90, 4
    v_cndmask_b32 v90, v90, v95, vcc
    v_cmp_eq_u32 s[18:19], 0, v90
    v_cmp_eq_u32 s[20:21], 1, v90
    v_cmp_eq_u32 vcc, 2, v90
    v_cndmask_b32 v116, 0, v89, s[18:19]
    v_cmp_eq_u32 s[18:19], 3, v90
    v_cndmask_b32 v117, 0, v89, s[20:21]
    v_cndmask_b32 v118, 0, v89, vcc
    v_cndmask_b32 v119, 0, v89, s[18:19]
    v_cmp_gt_u32 vcc, 2, v95
    v_and_b32 v91, 1, v95
    v_lshlrev_b32 v91, 4, v91
    v_lshlrev_b32 v91, v91, v89
    v_cndmask_b32 v120, 0, v91, vcc
    v_xor_b32 v121, v120, v91
    s_mov_b32 s20, 0xbfb8aa3b
    s_mov_b32 s21, 0xbfb8aa3b
    v_and_b32 v88, 8, v1
    v_cmp_eq_u32 vcc, 0, v88
    s_waitcnt lgkmcnt(0)
    v_lshlrev_b32 v84, 16, v84
    v_lshlrev_b32 v85, 16, v85
    v_lshlrev_b32 v86, 16, v86
    v_lshlrev_b32 v87, 16, v87
    v_pk_mul_f32 v[84:85], v[84:85], s[20:21]
    v_pk_mul_f32 v[86:87], v[86:87], s[20:21]
    v_cvt_pk_bf16_f32 v84, v84, v85
    v_cvt_pk_bf16_f32 v85, v86, v87
    v_cndmask_b32 v112, 0, v84, vcc
    v_cndmask_b32 v113, 0, v85, vcc
    v_xor_b32 v114, v112, v84
    v_xor_b32 v115, v113, v85
    s_waitcnt vmcnt(0)
    s_mov_b64 exec, 1
    ds_add_rtn_u32 v4, v30, v31 offset:12
    ds_read_b64 v[6:7], v30 offset:40
    s_lshl_b32 s18, s4, 9
    s_lshl_b32 s19, s5, 3
    s_add_u32 s18, s18, s19
    s_add_u32 s18, s18, 7340032
    v_mov_b32 v3, 0
    s_waitcnt lgkmcnt(0)
    v_readfirstlane_b32 s19, v4
    s_cmp_lg_u32 s19, 12
    s_cbranch_scc1 L_sig2a
    buffer_store_dwordx2 v[6:7], v3, s[68:71], s18 offen sc1
L_sig2a:
    s_mov_b64 exec, -1
    v_lshrrev_b32 v2, 3, v1
    v_mul_u32_u24 v2, 24576, v2
    v_and_b32 v3, 7, v1
    v_lshl_add_u32 v2, v3, 4, v2
    s_mul_i32 s25, s17, 786432
    s_mul_i32 s19, s5, 384
    s_add_u32 s25, s25, s19
    s_lshl_b32 s28, s17, 12
    v_mov_b32 v34, 1
    v_and_b32 v78, 31, v1
    v_lshlrev_b32 v78, 16, v78
    v_add_u32 v78, 0x620c80fc, v78
    v_lshl_add_u32 v80, s17, 6, v1
    s_movk_i32 s18, 392
    v_cmp_gt_u32 s[10:11], s18, v80
    v_lshlrev_b32 v64, 2, v80
    s_branch L_s1
L_sw:
    s_mov_b64 exec, -1
    s_mov_b32 s16, 1
    s_setprio 0
    v_lshrrev_b32 v2, 3, v1
    v_mul_u32_u24 v2, 24576, v2
    v_and_b32 v3, 7, v1
    v_lshl_add_u32 v2, v3, 4, v2
    s_mul_i32 s25, s17, 786432
    s_mul_i32 s19, s5, 384
    s_add_u32 s25, s25, s19
    s_lshl_b32 s28, s17, 12
    v_mov_b32 v34, 1
    v_mov_b32 v14, 780
    s_add_u32 s31, s25, 196608
    s_add_u32 s32, s25, 393216
    s_add_u32 s33, s25, 589824
L_hd:
    ds_read_b32 v32, v14 offset:12
    s_waitcnt lgkmcnt(0)
    v_readfirstlane_b32 s18, v32
    s_cmp_ge_u32 s18, 5
    s_cbranch_scc1 L_hdd
    s_sleep 1
    s_branch L_hd
L_hdd:
    buffer_load_dwordx4 v[48:51], v2, s[68:71], s25 offen offset:256 sc1
    buffer_load_dwordx4 v[52:55], v2, s[68:71], s31 offen offset:256 sc1
    buffer_load_dwordx4 v[56:59], v2, s[68:71], s32 offen offset:256 sc1
    buffer_load_dwordx4 v[60:63], v2, s[68:71], s33 offen offset:256 sc1
L_c2:
    ds_read_b32 v84, v14 offset:8
    s_waitcnt lgkmcnt(0)
    v_readfirstlane_b32 s18, v84
    s_cmp_ge_u32 s18, 2
    s_cbranch_scc1 L_c2d
    s_sleep 1
    s_branch L_c2
L_c2d:
    v_and_b32 v92, 7, v1
    v_lshrrev_b32 v93, 4, v1
    v_lshl_add_u32 v88, v92, 2, v93
    v_lshlrev_b32 v88, 1, v88
    ds_read_u16 v84, v88 offset:3712
    ds_read_u16 v85, v88 offset:3776
    ds_read_u16 v86, v88 offset:3840
    ds_read_u16 v87, v88 offset:3904
    v_bfe_u32 v94, v1, 2, 2
    v_and_b32 v95, 3, v1
    v_cmp_eq_u32 s[36:37], v93, v95
    v_mul_u32_u24 v122, 6288, v92
    v_add_u32 v122, 113536, v122
    s_mul_i32 s18, s5, 100352
    s_lshl_b32 s19, s4, 6
    s_add_u32 s18, s18, s19
    v_lshl_add_u32 v123, v92, 3, s18
    v_cmp_eq_u32 vcc, v94, v93
    v_mov_b32 v89, 0x3f80
    v_mov_b32 v90, 4
    v_cndmask_b32 v90, v90, v95, vcc
    v_cmp_eq_u32 s[18:19], 0, v90
    v_cmp_eq_u32 s[20:21], 1, v90
    v_cmp_eq_u32 vcc, 2, v90
    v_cndmask_b32 v116, 0, v89, s[18:19]
    v_cmp_eq_u32 s[18:19], 3, v90
    v_cndmask_b32 v117, 0, v89, s[20:21]
    v_cndmask_b32 v118, 0, v89, vcc
    v_cndmask_b32 v119, 0, v89, s[18:19]
    v_cmp_gt_u32 vcc, 2, v95
    v_and_b32 v91, 1, v95
    v_lshlrev_b32 v91, 4, v91
    v_lshlrev_b32 v91, v91, v89
    v_cndmask_b32 v120, 0, v91, vcc
    v_xor_b32 v121, v120, v91
    s_mov_b32 s20, 0xbfb8aa3b
    s_mov_b32 s21, 0xbfb8aa3b
    v_and_b32 v88, 8, v1
    v_cmp_eq_u32 vcc, 0, v88
    s_waitcnt lgkmcnt(0)
    v_lshlrev_b32 v84, 16, v84
    v_lshlrev_b32 v85, 16, v85
    v_lshlrev_b32 v86, 16, v86
    v_lshlrev_b32 v87, 16, v87
    v_pk_mul_f32 v[84:85], v[84:85], s[20:21]
    v_pk_mul_f32 v[86:87], v[86:87], s[20:21]
    v_cvt_pk_bf16_f32 v84, v84, v85
    v_cvt_pk_bf16_f32 v85, v86, v87
    v_cndmask_b32 v112, 0, v84, vcc
    v_cndmask_b32 v113, 0, v85, vcc
    v_xor_b32 v114, v112, v84
    v_xor_b32 v115, v113, v85
L_nw:
    ds_read_b64 v[46:47], v14 offset:28
    s_waitcnt lgkmcnt(0)
    v_readfirstlane_b32 s18, v47
    s_cmp_lg_u32 s18, 0
    s_cbranch_scc1 L_nwd
    s_sleep 1
    s_branch L_nw
L_nwd:
    v_and_b32 v45, 7, v1
    v_cmp_eq_u32 vcc, 0, v45
    v_lshlrev_b32 v45, 2, v45
    v_lshrrev_b64 v[46:47], v45, v[46:47]
    v_mov_b32 v44, 0xf803
    v_cndmask_b32 v44, v44, 2, vcc
    v_and_b32 v40, v44, v46
    v_lshrrev_b32 v41, 5, v46
    v_lshrrev_b32 v42, 10, v46
    v_lshrrev_b32 v43, 15, v46
    v_and_b32 v41, 0xf803, v41
    v_and_b32 v42, 0xf803, v42
    v_and_b32 v43, 0xf803, v43
    v_mov_b32 v26, 0
    v_mov_b32 v3, 0
    v_lshlrev_b32 v38, 4, v1
    s_lshl_b32 s22, s17, 20
    s_lshl_b32 s27, s5, 9
    s_add_u32 s22, s22, s27
    s_add_u32 s22, s22, 8388608
    s_mov_b64 s[6:7], -1
    s_mov_b64 s[8:9], -1
    s_mov_b64 s[10:11], -1
    s_mov_b64 s[12:13], -1
    s_mov_b32 s26, 0x0f0f0f0f
    s_mov_b32 s27, s26
    s_movk_i32 s21, 2048
    s_mov_b32 s23, 0xf803
    s_cmp_ge_u32 s3, 5
    s_cbranch_scc1 L_sig2b
    s_waitcnt vmcnt(4)
    s_mov_b64 exec, 1
    ds_add_rtn_u32 v4, v14, v31 offset:0
    ds_read_b64 v[6:7], v14 offset:28
    s_lshl_b32 s18, s4, 9
    s_lshl_b32 s19, s5, 3
    s_add_u32 s18, s18, s19
    s_add_u32 s18, s18, 7340032
    v_mov_b32 v3, 0
    s_waitcnt lgkmcnt(0)
    v_readfirstlane_b32 s19, v4
    s_cmp_lg_u32 s19, 12
    s_cbranch_scc1 L_sig2b
    buffer_store_dwordx2 v[6:7], v3, s[68:71], s18 offen sc1
L_sig2b:
    s_mov_b64 exec, -1
    v_mov_b64 v[64:65], 0
    v_mov_b64 v[66:67], 0
    v_mov_b64 v[68:69], 0
    v_mov_b64 v[70:71], 0
    v_mov_b64 v[72:73], 0
    v_mov_b64 v[74:75], 0
    v_mov_b64 v[76:77], 0
    v_mov_b64 v[78:79], 0
L_sv1:
    s_mov_b32 s20, 0
    s_waitcnt vmcnt(0)
    s_and_b64 exec, s[6:7], s[6:7]
    s_cbranch_scc0 L_sq0
    v_xor_b32 v48, v48, v40
    v_xor_b32 v49, v49, v41
    v_xor_b32 v50, v50, v42
    v_xor_b32 v51, v51, v43
    v_and_b32 v45, v48, v44
    v_or3_b32 v46, v49, v50, v51
    v_and_or_b32 v45, v46, s23, v45
    v_cmp_ne_u32 vcc, 0, v45
    s_wqm_b64 s[6:7], vcc
    s_cbranch_scc0 L_sq0
    s_lshr_b64 s[14:15], s[6:7], 4
    s_or_b64 s[6:7], s[6:7], s[14:15]
    s_and_b64 s[6:7], s[6:7], s[26:27]
    s_lshl_b64 s[14:15], s[6:7], 4
    s_or_b64 s[6:7], s[6:7], s[14:15]
    s_mov_b64 exec, s[6:7]
    s_mov_b32 s20, 1
    buffer_load_dwordx4 v[48:51], v2, s[68:71], s25 offen offset:256 sc1
L_sq0:
    s_and_b64 exec, s[8:9], s[8:9]
    s_cbranch_scc0 L_sq1
    v_xor_b32 v52, v52, v40
    v_xor_b32 v53, v53, v41
    v_xor_b32 v54, v54, v42
    v_xor_b32 v55, v55, v43
    v_and_b32 v45, v52, v44
    v_or3_b32 v46, v53, v54, v55
    v_and_or_b32 v45, v46, s23, v45
    v_cmp_ne_u32 vcc, 0, v45
    s_wqm_b64 s[8:9], vcc
    s_cbranch_scc0 L_sq1
    s_lshr_b64 s[14:15], s[8:9], 4
    s_or_b64 s[8:9], s[8:9], s[14:15]
    s_and_b64 s[8:9], s[8:9], s[26:27]
    s_lshl_b64 s[14:15], s[8:9], 4
    s_or_b64 s[8:9], s[8:9], s[14:15]
    s_mov_b64 exec, s[8:9]
    s_mov_b32 s20, 1
    buffer_load_dwordx4 v[52:55], v2, s[68:71], s31 offen offset:256 sc1
L_sq1:
    s_and_b64 exec, s[10:11], s[10:11]
    s_cbranch_scc0 L_sq2
    v_xor_b32 v56, v56, v40
    v_xor_b32 v57, v57, v41
    v_xor_b32 v58, v58, v42
    v_xor_b32 v59, v59, v43
    v_and_b32 v45, v56, v44
    v_or3_b32 v46, v57, v58, v59
    v_and_or_b32 v45, v46, s23, v45
    v_cmp_ne_u32 vcc, 0, v45
    s_wqm_b64 s[10:11], vcc
    s_cbranch_scc0 L_sq2
    s_lshr_b64 s[14:15], s[10:11], 4
    s_or_b64 s[10:11], s[10:11], s[14:15]
    s_and_b64 s[10:11], s[10:11], s[26:27]
    s_lshl_b64 s[14:15], s[10:11], 4
    s_or_b64 s[10:11], s[10:11], s[14:15]
    s_mov_b64 exec, s[10:11]
    s_mov_b32 s20, 1
    buffer_load_dwordx4 v[56:59], v2, s[68:71], s32 offen offset:256 sc1
L_sq2:
    s_and_b64 exec, s[12:13], s[12:13]
    s_cbranch_scc0 L_sq3
    v_xor_b32 v60, v60, v40
    v_xor_b32 v61, v61, v41
    v_xor_b32 v62, v62, v42
    v_xor_b32 v63, v63, v43
    v_and_b32 v45, v60, v44
    v_or3_b32 v46, v61, v62, v63
    v_and_or_b32 v45, v46, s23, v45
    v_cmp_ne_u32 vcc, 0, v45
    s_wqm_b64 s[12:13], vcc
    s_cbranch_scc0 L_sq3
    s_lshr_b64 s[14:15], s[12:13], 4
    s_or_b64 s[12:13], s[12:13], s[14:15]
    s_and_b64 s[12:13], s[12:13], s[26:27]
    s_lshl_b64 s[14:15], s[12:13], 4
    s_or_b64 s[12:13], s[12:13], s[14:15]
    s_mov_b64 exec, s[12:13]
    s_mov_b32 s20, 1
    buffer_load_dwordx4 v[60:63], v2, s[68:71], s33 offen offset:256 sc1
L_sq3:
    s_mov_b64 exec, -1
    s_cmp_eq_u32 s20, 0
    s_cbranch_scc1 L_svd
    s_sub_u32 s21, s21, 1
    s_cbranch_scc0 L_sv1
    s_waitcnt vmcnt(0)
    v_mov_b32 v39, 768
    ds_or_b32 v39, v34
    v_mov_b32 v48, 0x800007fc
    v_mov_b32 v49, 0x800007fc
    v_mov_b32 v50, 0x800007fc
    v_mov_b32 v51, 0x800007fc
    v_mov_b32 v52, 0x800007fc
    v_mov_b32 v53, 0x800007fc
    v_mov_b32 v54, 0x800007fc
    v_mov_b32 v55, 0x800007fc
    v_mov_b32 v56, 0x800007fc
    v_mov_b32 v57, 0x800007fc
    v_mov_b32 v58, 0x800007fc
    v_mov_b32 v59, 0x800007fc
    v_mov_b32 v60, 0x800007fc
    v_mov_b32 v61, 0x800007fc
    v_mov_b32 v62, 0x800007fc
    v_mov_b32 v63, 0x800007fc
L_svd:
    v_bfe_u32 v45, v52, 11, 5
    v_bfe_u32 v46, v56, 11, 5
    v_bfe_u32 v47, v60, 11, 5
    v_bfe_u32 v36, v48, 11, 5
    v_mov_b32_dpp v45, v45 row_shr:1 row_mask:0xf bank_mask:0xf bound_ctrl:0
    v_mov_b32_dpp v46, v46 row_shr:2 row_mask:0xf bank_mask:0xf bound_ctrl:0
    v_mov_b32_dpp v47, v47 row_shr:3 row_mask:0xf bank_mask:0xf bound_ctrl:0
    v_or_b32 v36, v36, v45
    v_or3_b32 v36, v36, v46, v47
    v_or3_b32 v45, v48, v52, v56
    v_or_b32 v45, v45, v60
    v_cmp_ne_u32 s[14:15], 0, v36
    v_and_b32 v45, 1, v45
    v_mov_b32 v39, 768
    v_mov_b32 v28, 0
    v_mov_b32 v29, 0
    v_mov_b32 v30, 0x800007fc
    s_mov_b32 s24, 0
    v_cmpx_ne_u32 vcc, 0, v45
    ds_or_b32 v39, v34
    s_cbranch_vccnz L_ovd
L_ov:
    s_cmp_eq_u64 s[14:15], 0
    s_cbranch_scc1 L_ovd
    s_ff1_i32_b64 s23, s[14:15]
    s_bitset0_b64 s[14:15], s23
    v_readlane_b32 s26, v36, s23
    s_and_b32 s27, s23, 7
    s_lshl_b32 s27, s27, 18
    s_lshr_b32 s23, s23, 3
    s_lshl_b32 s23, s23, 15
    s_add_u32 s23, s23, s27
    s_add_u32 s23, s23, s22
    s_lshl_b32 s27, s24, 4
    s_sub_u32 s23, s23, s27
    s_bfm_b64 exec, s26, s24
    s_add_u32 s24, s24, s26
    s_cmp_gt_u32 s24, 63
    s_cbranch_scc1 L_ovbad
    buffer_load_dwordx4 v[28:31], v38, s[68:71], s23 offen sc1
    s_branch L_ov
L_ovbad:
    s_mov_b64 exec, 1
    ds_or_b32 v39, v34
L_ovd:
    s_mov_b64 exec, -1
    v_and_b32 v80, 0x7fc, v48
    v_cmpx_le_i32 vcc, 0, v48
    ds_add_rtn_u32 v64, v80, v34 offset:2048
    s_mov_b64 exec, -1
    v_and_b32 v81, 0x7fc, v49
    v_cmpx_le_i32 vcc, 0, v49
    ds_add_rtn_u32 v65, v81, v34 offset:2048
    s_mov_b64 exec, -1
    v_and_b32 v82, 0x7fc, v50
    v_cmpx_le_i32 vcc, 0, v50
    ds_add_rtn_u32 v66, v82, v34 offset:2048
    s_mov_b64 exec, -1
    v_and_b32 v83, 0x7fc, v51
    v_cmpx_le_i32 vcc, 0, v51
    ds_add_rtn_u32 v67, v83, v34 offset:2048
    s_mov_b64 exec, -1
    v_and_b32 v84, 0x7fc, v52
    v_cmpx_le_i32 vcc, 0, v52
    ds_add_rtn_u32 v68, v84, v34 offset:2048
    s_mov_b64 exec, -1
    v_and_b32 v85, 0x7fc, v53
    v_cmpx_le_i32 vcc, 0, v53
    ds_add_rtn_u32 v69, v85, v34 offset:2048
    s_mov_b64 exec, -1
    v_and_b32 v86, 0x7fc, v54
    v_cmpx_le_i32 vcc, 0, v54
    ds_add_rtn_u32 v70, v86, v34 offset:2048
    s_mov_b64 exec, -1
    v_and_b32 v87, 0x7fc, v55
    v_cmpx_le_i32 vcc, 0, v55
    ds_add_rtn_u32 v71, v87, v34 offset:2048
    s_mov_b64 exec, -1
    v_and_b32 v88, 0x7fc, v56
    v_cmpx_le_i32 vcc, 0, v56
    ds_add_rtn_u32 v72, v88, v34 offset:2048
    s_mov_b64 exec, -1
    v_and_b32 v89, 0x7fc, v57
    v_cmpx_le_i32 vcc, 0, v57
    ds_add_rtn_u32 v73, v89, v34 offset:2048
    s_mov_b64 exec, -1
    v_and_b32 v90, 0x7fc, v58
    v_cmpx_le_i32 vcc, 0, v58
    ds_add_rtn_u32 v74, v90, v34 offset:2048
    s_mov_b64 exec, -1
    v_and_b32 v91, 0x7fc, v59
    v_cmpx_le_i32 vcc, 0, v59
    ds_add_rtn_u32 v75, v91, v34 offset:2048
    s_mov_b64 exec, -1
    v_and_b32 v92, 0x7fc, v60
    v_cmpx_le_i32 vcc, 0, v60
    ds_add_rtn_u32 v76, v92, v34 offset:2048
    s_mov_b64 exec, -1
    v_and_b32 v93, 0x7fc, v61
    v_cmpx_le_i32 vcc, 0, v61
    ds_add_rtn_u32 v77, v93, v34 offset:2048
    s_mov_b64 exec, -1
    v_and_b32 v94, 0x7fc, v62
    v_cmpx_le_i32 vcc, 0, v62
    ds_add_rtn_u32 v78, v94, v34 offset:2048
    s_mov_b64 exec, -1
    v_and_b32 v95, 0x7fc, v63
    v_cmpx_le_i32 vcc, 0, v63
    ds_add_rtn_u32 v79, v95, v34 offset:2048
    s_mov_b64 exec, -1
L_e5:
    ds_read_b32 v32, v14 offset:12
    s_waitcnt lgkmcnt(0)
    v_readfirstlane_b32 s18, v32
    s_cmp_ge_u32 s18, 5
    s_cbranch_scc1 L_e5d
    s_sleep 1
    s_branch L_e5
L_e5d:
    s_add_u32 m0, s28, 4096
    s_add_u32 s19, s25, 0
    buffer_load_dwordx4 v2, s[68:71], s19 offen offset:0 sc1 lds
    v_lshlrev_b32 v37, 2, v1
    s_lshl_b32 s18, s17, 8
    s_add_u32 s18, s18, 32768
    v_add_u32 v37, s18, v37
    s_mov_b32 s18, 0xffff0000
    v_lshl_add_u32 v36, v1, 4, s28
    v_and_or_b32 v48, v48, s18, v36
    v_add_u32 v38, 4, v36
    v_and_or_b32 v49, v49, s18, v38
    v_add_u32 v38, 8, v36
    v_and_or_b32 v50, v50, s18, v38
    v_add_u32 v38, 12, v36
    v_and_or_b32 v51, v51, s18, v38
    v_add_u32 v38, 1024, v36
    v_and_or_b32 v52, v52, s18, v38
    v_add_u32 v38, 1028, v36
    v_and_or_b32 v53, v53, s18, v38
    v_add_u32 v38, 1032, v36
    v_and_or_b32 v54, v54, s18, v38
    v_add_u32 v38, 1036, v36
    v_and_or_b32 v55, v55, s18, v38
    v_add_u32 v38, 2048, v36
    v_and_or_b32 v56, v56, s18, v38
    v_add_u32 v38, 2052, v36
    v_and_or_b32 v57, v57, s18, v38
    v_add_u32 v38, 2056, v36
    v_and_or_b32 v58, v58, s18, v38
    v_add_u32 v38, 2060, v36
    v_and_or_b32 v59, v59, s18, v38
    v_add_u32 v38, 3072, v36
    v_and_or_b32 v60, v60, s18, v38
    v_add_u32 v38, 3076, v36
    v_and_or_b32 v61, v61, s18, v38
    v_add_u32 v38, 3080, v36
    v_and_or_b32 v62, v62, s18, v38
    v_add_u32 v38, 3084, v36
    v_and_or_b32 v63, v63, s18, v38
    s_waitcnt vmcnt(1)
    v_and_b32 v27, 0x7fc, v30
    v_cmpx_le_i32 vcc, 0, v30
    ds_add_rtn_u32 v26, v27, v34 offset:2048
    s_mov_b64 exec, -1
    v_and_or_b32 v30, v30, s18, v37
L_s1:
    v_lshlrev_b32 v35, 2, v1
    s_lshl_b32 s35, s16, 3
    s_or_b32 s35, s35, s17
    s_cmp_eq_u32 s3, 12
    s_cselect_b32 s26, 0xff, -1
    s_cselect_b32 s27, 0xff, -1
    s_waitcnt lgkmcnt(0)
    s_barrier
    s_cmp_eq_u32 s16, 1
    s_cbranch_scc1 L_s2e
    ds_read_b32 v66, v64 offset:2048
    s_waitcnt lgkmcnt(0)
    v_min_u32 v67, 63, v66
    v_sub_u32 v67, 63, v67
    v_lshlrev_b32 v67, 2, v67
    s_mov_b64 exec, s[10:11]
    ds_add_rtn_u32 v68, v67, v34 offset:256
    s_mov_b64 exec, s[26:27]
    ds_write_b128 v10, v[96:99] offset:0
    ds_write_b128 v10, v[100:103] offset:12576
    ds_write_b128 v10, v[104:107] offset:25152
    ds_write_b128 v10, v[108:111] offset:37728
    s_mov_b64 exec, -1
    s_waitcnt lgkmcnt(4)
    s_barrier
    s_branch L_s2d
L_s2e:
    s_add_u32 m0, s28, 4096
    s_add_u32 s19, s25, 195584
    buffer_load_dwordx4 v2, s[68:71], s19 offen offset:1024 sc1 lds
    s_add_u32 m0, s28, 4096
    s_add_u32 s19, s25, 391168
    buffer_load_dwordx4 v2, s[68:71], s19 offen offset:2048 sc1 lds
    s_barrier
    s_add_u32 m0, s28, 4096
    s_add_u32 s19, s25, 586752
    buffer_load_dwordx4 v2, s[68:71], s19 offen offset:3072 sc1 lds
    s_add_u32 m0, s28, 38912
    s_add_u32 s19, s25, 128
    buffer_load_dwordx4 v2, s[68:71], s19 offen offset:0 sc1 lds
    ds_write2st64_b32 v37, v28, v29 offset0:16 offset1:152
    s_cmp_ge_u32 s3, 13
    s_cbranch_scc1 L_s2f
L_s2g:
    s_mov_b64 exec, s[26:27]
    ds_write_b128 v10, v[96:99] offset:0
    ds_write_b128 v10, v[100:103] offset:12576
    ds_write_b128 v10, v[104:107] offset:25152
    ds_write_b128 v10, v[108:111] offset:37728
    s_mov_b64 exec, -1
L_s2f:
L_s2d:
    s_cmp_gt_u32 s35, 6
    s_cbranch_scc1 L_s3d
    ds_read_b32 v69, v35 offset:256
    s_waitcnt lgkmcnt(0)
    v_mov_b32 v70, v69
    s_nop 1
    v_add_u32_dpp v70, v70, v70 row_shr:1 row_mask:0xf bank_mask:0xf bound_ctrl:0
    s_nop 1
    v_add_u32_dpp v70, v70, v70 row_shr:2 row_mask:0xf bank_mask:0xf bound_ctrl:0
    s_nop 1
    v_add_u32_dpp v70, v70, v70 row_shr:4 row_mask:0xf bank_mask:0xf bound_ctrl:0
    s_nop 1
    v_add_u32_dpp v70, v70, v70 row_shr:8 row_mask:0xf bank_mask:0xf bound_ctrl:0
    s_nop 1
    v_add_u32_dpp v70, v70, v70 row_bcast:15 row_mask:0xa bank_mask:0xf
    s_nop 1
    v_add_u32_dpp v70, v70, v70 row_bcast:31 row_mask:0xc bank_mask:0xf
    v_sub_u32 v70, v70, v69
    ds_bpermute_b32 v70, v67, v70
    v_max_u32 v65, 2, v66
    s_waitcnt lgkmcnt(0)
    v_add_u32 v70, v70, v68
    v_and_b32 v71, 7, v70
    v_lshrrev_b32 v72, 7, v70
    v_bfe_u32 v73, v70, 3, 4
    v_bfe_i32 v74, v70, 7, 1
    v_and_b32 v74, 15, v74
    v_xor_b32 v73, v73, v74
    v_lshl_add_u32 v74, v73, 2, v72
    v_lshlrev_b32 v74, 2, v74
    v_lshl_add_u32 v73, v73, 3, v71
    v_lshlrev_b32 v73, 3, v73
    v_lshl_add_u32 v73, v72, 1, v73
    s_mov_b64 exec, s[10:11]
    ds_max_u32 v74, v65 offset:512
    ds_write_b16 v73, v80 offset:1024
    s_mov_b64 exec, -1
L_s3d:
    s_waitcnt lgkmcnt(0)
    s_barrier
    ds_read_b32 v40, v35 offset:512
    v_mov_b32 v42, 768
    ds_read_b32 v42, v42
    s_lshl_b32 s18, s3, 2
    s_add_u32 s19, s18, 1
    s_add_u32 s20, s18, 2
    s_add_u32 s21, s18, 3
    s_waitcnt lgkmcnt(0)
    v_mov_b32 v41, v40
    v_readfirstlane_b32 s22, v42
    s_nop 1
    v_add_u32_dpp v41, v41, v41 row_shr:1 row_mask:0xf bank_mask:0xf bound_ctrl:0
    s_nop 1
    v_add_u32_dpp v41, v41, v41 row_shr:2 row_mask:0xf bank_mask:0xf bound_ctrl:0
    s_nop 1
    v_add_u32_dpp v41, v41, v41 row_shr:4 row_mask:0xf bank_mask:0xf bound_ctrl:0
    s_nop 1
    v_add_u32_dpp v41, v41, v41 row_shr:8 row_mask:0xf bank_mask:0xf bound_ctrl:0
    s_nop 1
    v_add_u32_dpp v41, v41, v41 row_bcast:15 row_mask:0xa bank_mask:0xf
    s_nop 1
    v_add_u32_dpp v41, v41, v41 row_bcast:31 row_mask:0xc bank_mask:0xf
    s_nop 0
    v_readlane_b32 s23, v41, 63
    v_sub_u32 v41, v41, v40
    v_readlane_b32 s30, v40, s18
    v_readlane_b32 s31, v40, s19
    v_readlane_b32 s32, v40, s20
    v_readlane_b32 s33, v40, s21
    v_readlane_b32 s34, v41, s18
    s_cmp_gt_u32 s23, 1008
    s_cselect_b32 s22, 1, s22
    s_cmp_lg_u32 s22, 0
    s_cbranch_scc1 L_slow
    s_cmp_gt_u32 s35, 6
    s_cbranch_scc1 L_s4e
    ds_bpermute_b32 v70, v74, v41
    ds_bpermute_b32 v75, v74, v40
    v_lshlrev_b32 v71, 2, v71
    v_add_u32 v71, 73728, v71
    v_mov_b32 v72, 4092
    v_mov_b32 v73, 816
    ds_write_b32 v72, v73
    s_waitcnt lgkmcnt(0)
    v_lshl_add_u32 v70, v70, 5, v71
    s_mov_b64 exec, s[10:11]
    ds_write_b32 v64, v70 offset:2048
    s_mov_b64 exec, -1
    s_branch L_s4d
L_s4e:
    s_cmp_lg_u32 s16, 1
    s_cbranch_scc1 L_s4d
    s_add_u32 m0, s28, 38912
    s_add_u32 s19, s25, 195712
    buffer_load_dwordx4 v2, s[68:71], s19 offen offset:1024 sc1 lds
    s_add_u32 m0, s28, 38912
    s_add_u32 s19, s25, 391296
    buffer_load_dwordx4 v2, s[68:71], s19 offen offset:2048 sc1 lds
L_s4d:
    s_waitcnt lgkmcnt(0)
    s_barrier
    s_cmp_eq_u32 s16, 1
    s_cbranch_scc1 L_s5
    s_cmp_lg_u32 s3, 12
    s_cbranch_scc1 L_ni2a
    v_lshlrev_b32 v20, 3, v1
    s_lshl_b32 s12, s4, 9
    s_add_u32 s12, s12, 7340032
    buffer_load_dwordx2 v[22:23], v20, s[68:71], s12 offen sc1
    v_mov_b32 v18, 808
    ds_read_b64 v[18:19], v18
    s_mov_b32 s13, 0x40000
L_ni2a:
    v_lshl_add_u32 v76, v66, 5, v70
    v_lshl_add_u32 v77, v75, 5, v70
    s_mov_b64 exec, s[10:11]
L_pad:
    v_cmpx_lt_u32 vcc, v76, v77
    s_cbranch_execz L_padd
    ds_write_b32 v76, v78
    v_add_u32 v76, 32, v76
    s_branch L_pad
L_padd:
    s_mov_b64 exec, -1
    s_branch L_s5d
L_s5:
    ds_read_b32 v80, v80 offset:2048
    ds_read_b32 v81, v81 offset:2048
    ds_read_b32 v82, v82 offset:2048
    ds_read_b32 v83, v83 offset:2048
    ds_read_b32 v84, v84 offset:2048
    ds_read_b32 v85, v85 offset:2048
    ds_read_b32 v86, v86 offset:2048
    ds_read_b32 v87, v87 offset:2048
    s_add_u32 m0, s28, 38912
    s_add_u32 s19, s25, 586880
    buffer_load_dwordx4 v2, s[68:71], s19 offen offset:3072 sc1 lds
    s_waitcnt lgkmcnt(7)
    v_lshl_add_u32 v80, v64, 5, v80
    ds_write_b32 v80, v48
    s_waitcnt lgkmcnt(7)
    v_lshl_add_u32 v81, v65, 5, v81
    ds_write_b32 v81, v49
    s_waitcnt lgkmcnt(7)
    v_lshl_add_u32 v82, v66, 5, v82
    ds_write_b32 v82, v50
    s_waitcnt lgkmcnt(7)
    v_lshl_add_u32 v83, v67, 5, v83
    ds_write_b32 v83, v51
    s_waitcnt lgkmcnt(7)
    v_lshl_add_u32 v84, v68, 5, v84
    ds_write_b32 v84, v52
    s_waitcnt lgkmcnt(7)
    v_lshl_add_u32 v85, v69, 5, v85
    ds_write_b32 v85, v53
    s_waitcnt lgkmcnt(7)
    v_lshl_add_u32 v86, v70, 5, v86
    ds_write_b32 v86, v54
    s_waitcnt lgkmcnt(7)
    v_lshl_add_u32 v87, v71, 5, v87
    ds_write_b32 v87, v55
    ds_read_b32 v88, v88 offset:2048
    ds_read_b32 v89, v89 offset:2048
    ds_read_b32 v90, v90 offset:2048
    ds_read_b32 v91, v91 offset:2048
    ds_read_b32 v92, v92 offset:2048
    ds_read_b32 v93, v93 offset:2048
    ds_read_b32 v94, v94 offset:2048
    ds_read_b32 v95, v95 offset:2048
    ds_read_b32 v27, v27 offset:2048
    s_waitcnt lgkmcnt(8)
    v_lshl_add_u32 v88, v72, 5, v88
    ds_write_b32 v88, v56
    s_waitcnt lgkmcnt(8)
    v_lshl_add_u32 v89, v73, 5, v89
    ds_write_b32 v89, v57
    s_waitcnt lgkmcnt(8)
    v_lshl_add_u32 v90, v74, 5, v90
    ds_write_b32 v90, v58
    s_waitcnt lgkmcnt(8)
    v_lshl_add_u32 v91, v75, 5, v91
    ds_write_b32 v91, v59
    s_waitcnt lgkmcnt(8)
    v_lshl_add_u32 v92, v76, 5, v92
    ds_write_b32 v92, v60
    s_waitcnt lgkmcnt(8)
    v_lshl_add_u32 v93, v77, 5, v93
    ds_write_b32 v93, v61
    s_waitcnt lgkmcnt(8)
    v_lshl_add_u32 v94, v78, 5, v94
    ds_write_b32 v94, v62
    s_waitcnt lgkmcnt(8)
    v_lshl_add_u32 v95, v79, 5, v95
    ds_write_b32 v95, v63
    s_waitcnt lgkmcnt(8)
    v_lshl_add_u32 v27, v26, 5, v27
    ds_write_b32 v27, v30
L_s5d:
    v_lshrrev_b32 v2, 3, v1
    s_lshl_b32 s19, s3, 6
    v_lshl_add_u32 v7, v2, 3, s19
    ds_read_b64 v[106:107], v7 offset:1024
    v_bfe_u32 v4, v1, 2, 2
    v_and_b32 v3, 7, v1
    v_lshlrev_b32 v99, 4, v3
    v_lshlrev_b32 v101, 4, v3
    s_lshl_b32 s18, s34, 5
    s_add_u32 s18, s18, 73728
    s_add_u32 s19, s18, 2
    v_lshl_add_u32 v104, v2, 2, s19
    v_lshl_add_u32 v105, v4, 3, s18
    s_movk_i32 s35, 256
    s_movk_i32 s38, 256
    s_movk_i32 s39, 256
    s_mov_b32 s28, 0x420637bd
    s_mov_b32 s29, 0x420637bd
    s_sub_u32 s24, s30, 2
    s_mov_b32 s26, 0x47000000
    s_mov_b32 s27, 0x33000000
    s_mov_b32 s20, 0xc2200000
    s_mov_b32 s21, s20
    s_waitcnt lgkmcnt(0)
    v_mad_u32_u16 v109, v106, s35, v123
    v_mad_u32_u16 v108, v106, 16, v122
    s_mov_b32 s22, 0
    ds_read_b128 v[56:59], v108
    v_mad_u32_u16 v108, v106, 16, v122 op_sel:[1,0,0,0]
    ds_read_b128 v[60:63], v108
    v_mov_b64 v[48:49], 0
    v_mov_b64 v[50:51], 0
    v_mov_b64 v[52:53], 0
    v_mov_b64 v[54:55], 0
    v_mov_b64 v[28:29], s[28:29]
    v_mov_b64 v[30:31], s[28:29]
    v_mov_b64 v[32:33], 0
    v_mov_b64 v[34:35], 0
    v_mov_b64 v[24:25], s[20:21]
    v_mov_b64 v[26:27], s[20:21]
    s_cmp_lg_u32 s3, 12
    s_cbranch_scc1 L_np2a
    v_lshlrev_b32 v20, 3, v1
    s_waitcnt vmcnt(0) lgkmcnt(0)
L_poll2a:
    v_cmpx_ne_u64 vcc, v[18:19], v[22:23]
    s_sub_u32 s13, s13, 1
    s_cbranch_scc1 L_poll2da
    s_cbranch_vccz L_poll2da
    s_sleep 1
    buffer_load_dwordx2 v[22:23], v20, s[68:71], s12 offen sc1
    s_waitcnt vmcnt(0)
    s_branch L_poll2a
L_poll2da:
    s_mov_b64 exec, -1
L_np2a:
    s_cmp_lg_u32 s16, 1
    s_cbranch_scc1 L_s5w
    s_waitcnt vmcnt(0)
L_s5w:
    s_waitcnt lgkmcnt(0)
    v_mfma_f32_16x16x32_bf16 v[36:39], v[116:119], v[56:59], v[24:27]
    s_barrier
    s_setprio 3
    s_mov_b32 s23, 3
    ds_read_u16 v8, v104 offset:0
    ds_read_u16 v9, v104 offset:32
    ds_read_u16 v10, v104 offset:64
    ds_read_u16 v11, v104 offset:96
    ds_read_u16 v12, v104 offset:128
    ds_read_u16 v13, v104 offset:160
    ds_read_u16 v16, v105
    ds_read_u16 v17, v105 offset:4
    ds_read_u16 v18, v105 offset:32
    ds_read_u16 v19, v105 offset:36
    ds_read_u16 v100, v104 offset:192
    s_waitcnt lgkmcnt(10)
    v_lshl_add_u32 v8, v8, 7, v99
    buffer_load_dwordx4 v[64:67], v8, s[72:75], 0 offen sc1
    s_waitcnt lgkmcnt(1)
    s_mov_b64 exec, s[36:37]
    ds_read2st64_b32 v[48:49], v16 offset0:16 offset1:152
    ds_read2st64_b32 v[50:51], v17 offset0:16 offset1:152
    ds_read2st64_b32 v[52:53], v18 offset0:16 offset1:152
    ds_read2st64_b32 v[54:55], v19 offset0:16 offset1:152
    ds_read_u16 v102, v105 offset:64
    ds_read_u16 v103, v105 offset:68
    s_mov_b64 exec, -1
    s_waitcnt lgkmcnt(9)
    v_lshl_add_u32 v9, v9, 7, v99
    buffer_load_dwordx4 v[68:71], v9, s[72:75], 0 offen sc1
    s_waitcnt lgkmcnt(8)
    v_lshl_add_u32 v10, v10, 7, v99
    buffer_load_dwordx4 v[72:75], v10, s[72:75], 0 offen sc1
    s_waitcnt lgkmcnt(7)
    v_lshl_add_u32 v11, v11, 7, v99
    buffer_load_dwordx4 v[76:79], v11, s[72:75], 0 offen sc1
    s_waitcnt lgkmcnt(6)
    v_lshl_add_u32 v12, v12, 7, v99
    buffer_load_dwordx4 v[80:83], v12, s[72:75], 0 offen sc1
    s_waitcnt lgkmcnt(5)
    v_lshl_add_u32 v13, v13, 7, v99
    buffer_load_dwordx4 v[84:87], v13, s[72:75], 0 offen sc1
    s_waitcnt lgkmcnt(0)
    v_mfma_f32_16x16x32_bf16 v[40:43], v[48:51], v[112:115], v[36:39]
    s_waitcnt vmcnt(5)
    s_nop 4
    v_mfma_f32_16x16x32_bf16 v[40:43], v[116:119], v[64:67], v[40:43]
    s_mov_b64 exec, s[36:37]
    ds_read2st64_b32 v[48:49], v102 offset0:16 offset1:152
    ds_read2st64_b32 v[50:51], v103 offset0:16 offset1:152
    ds_read_u16 v102, v105 offset:96
    ds_read_u16 v103, v105 offset:100
    s_mov_b64 exec, -1
    s_waitcnt vmcnt(4)
    s_nop 1
    v_mfma_f32_16x16x32_bf16 v[44:47], v[52:55], v[112:115], v[36:39]
    v_exp_f32 v40, v40 clamp
    v_mfma_f32_16x16x32_bf16 v[44:47], v[116:119], v[68:71], v[44:47]
    v_exp_f32 v41, v41 clamp
    v_exp_f32 v42, v42 clamp
    v_exp_f32 v43, v43 clamp
L_m0_0:
    s_sub_u32 s24, s24, 1
    s_cbranch_scc1 L_b0_0
    s_waitcnt lgkmcnt(0)
    buffer_load_dwordx4 v[88:91], v[100:101], s[76:79], 0 idxen offen sc1
    s_mov_b64 exec, s[36:37]
    ds_read2st64_b32 v[52:53], v102 offset0:16 offset1:152
    ds_read2st64_b32 v[54:55], v103 offset0:16 offset1:152
    ds_read_u16 v102, v105 offset:128
    ds_read_u16 v103, v105 offset:132
    s_mov_b64 exec, -1
    ds_read_u16 v98, v104 offset:224
    s_waitcnt vmcnt(4)
    v_pk_fma_f32 v[12:13], v[40:41], s[26:27], s[26:27] op_sel:[0,0,1] op_sel_hi:[1,0,1]
    v_pk_fma_f32 v[14:15], v[42:43], s[26:27], s[26:27] op_sel:[0,0,1] op_sel_hi:[1,0,1]
    v_mfma_f32_16x16x32_bf16 v[40:43], v[48:51], v[112:115], v[36:39]
    v_exp_f32 v44, v44 clamp
    v_mfma_f32_16x16x32_bf16 v[40:43], v[116:119], v[72:75], v[40:43]
    v_exp_f32 v45, v45 clamp
    v_exp_f32 v46, v46 clamp
    v_exp_f32 v47, v47 clamp
L_m0_1:
    s_sub_u32 s24, s24, 1
    s_cbranch_scc1 L_b0_1
    s_waitcnt lgkmcnt(0)
    buffer_load_dwordx4 v[92:95], v[98:99], s[76:79], 0 idxen offen sc1
    s_mov_b64 exec, s[36:37]
    ds_read2st64_b32 v[48:49], v102 offset0:16 offset1:152
    ds_read2st64_b32 v[50:51], v103 offset0:16 offset1:152
    ds_read_u16 v102, v105 offset:160
    ds_read_u16 v103, v105 offset:164
    s_mov_b64 exec, -1
    ds_read_u16 v100, v104 offset:256
    s_waitcnt vmcnt(4)
    v_pk_fma_f32 v[44:45], v[44:45], s[26:27], s[26:27] op_sel:[0,0,1] op_sel_hi:[1,0,1]
    v_pk_fma_f32 v[46:47], v[46:47], s[26:27], s[26:27] op_sel:[0,0,1] op_sel_hi:[1,0,1]
    v_pk_mul_f32 v[16:17], v[44:45], v[64:65]
    v_pk_mul_f32 v[18:19], v[46:47], v[66:67]
    v_pk_add_f32 v[8:9], v[12:13], v[44:45]
    v_pk_add_f32 v[10:11], v[14:15], v[46:47]
    v_pk_fma_f32 v[16:17], v[12:13], v[68:69], v[16:17]
    v_pk_fma_f32 v[18:19], v[14:15], v[70:71], v[18:19]
    v_pk_mul_f32 v[12:13], v[12:13], v[44:45]
    v_pk_mul_f32 v[14:15], v[14:15], v[46:47]
    v_mfma_f32_16x16x32_bf16 v[44:47], v[52:55], v[112:115], v[36:39]
    v_exp_f32 v40, v40 clamp
    v_mfma_f32_16x16x32_bf16 v[44:47], v[116:119], v[76:79], v[44:47]
    v_exp_f32 v41, v41 clamp
    v_exp_f32 v42, v42 clamp
    v_exp_f32 v43, v43 clamp
L_m0_2:
    s_sub_u32 s24, s24, 1
    s_cbranch_scc1 L_b0_2
    s_waitcnt lgkmcnt(0)
    buffer_load_dwordx4 v[64:67], v[100:101], s[76:79], 0 idxen offen sc1
    s_mov_b64 exec, s[36:37]
    ds_read2st64_b32 v[52:53], v102 offset0:16 offset1:152
    ds_read2st64_b32 v[54:55], v103 offset0:16 offset1:152
    ds_read_u16 v102, v105 offset:192
    ds_read_u16 v103, v105 offset:196
    s_mov_b64 exec, -1
    ds_read_u16 v98, v104 offset:288
    s_waitcnt vmcnt(4)
    v_pk_fma_f32 v[40:41], v[40:41], s[26:27], s[26:27] op_sel:[0,0,1] op_sel_hi:[1,0,1]
    v_pk_fma_f32 v[42:43], v[42:43], s[26:27], s[26:27] op_sel:[0,0,1] op_sel_hi:[1,0,1]
    v_pk_mul_f32 v[16:17], v[16:17], v[40:41]
    v_pk_mul_f32 v[18:19], v[18:19], v[42:43]
    v_pk_fma_f32 v[8:9], v[8:9], v[40:41], v[12:13]
    v_pk_fma_f32 v[10:11], v[10:11], v[42:43], v[14:15]
    v_pk_fma_f32 v[16:17], v[72:73], v[12:13], v[16:17]
    v_pk_fma_f32 v[18:19], v[74:75], v[14:15], v[18:19]
    v_pk_mul_f32 v[12:13], v[12:13], v[40:41]
    v_pk_mul_f32 v[14:15], v[14:15], v[42:43]
    v_mfma_f32_16x16x32_bf16 v[40:43], v[48:51], v[112:115], v[36:39]
    v_exp_f32 v44, v44 clamp
    v_mfma_f32_16x16x32_bf16 v[40:43], v[116:119], v[80:83], v[40:43]
    v_exp_f32 v45, v45 clamp
    v_exp_f32 v46, v46 clamp
    v_exp_f32 v47, v47 clamp
L_m0_3:
    s_sub_u32 s24, s24, 1
    s_cbranch_scc1 L_b0_3
    s_waitcnt lgkmcnt(0)
    buffer_load_dwordx4 v[68:71], v[98:99], s[76:79], 0 idxen offen sc1
    s_mov_b64 exec, s[36:37]
    ds_read2st64_b32 v[48:49], v102 offset0:16 offset1:152
    ds_read2st64_b32 v[50:51], v103 offset0:16 offset1:152
    ds_read_u16 v102, v105 offset:224
    ds_read_u16 v103, v105 offset:228
    s_mov_b64 exec, -1
    ds_read_u16 v100, v104 offset:320
    s_waitcnt vmcnt(4)
    v_pk_fma_f32 v[44:45], v[44:45], s[26:27], s[26:27] op_sel:[0,0,1] op_sel_hi:[1,0,1]
    v_pk_fma_f32 v[46:47], v[46:47], s[26:27], s[26:27] op_sel:[0,0,1] op_sel_hi:[1,0,1]
    v_pk_mul_f32 v[20:21], v[12:13], v[44:45]
    v_pk_mul_f32 v[22:23], v[14:15], v[46:47]
    v_rcp_f32 v20, v20
    v_rcp_f32 v21, v21
    v_rcp_f32 v22, v22
    v_rcp_f32 v23, v23
    v_pk_mul_f32 v[16:17], v[16:17], v[44:45]
    v_pk_mul_f32 v[18:19], v[18:19], v[46:47]
    v_pk_fma_f32 v[8:9], v[8:9], v[44:45], v[12:13]
    v_pk_fma_f32 v[10:11], v[10:11], v[46:47], v[14:15]
    v_pk_fma_f32 v[16:17], v[76:77], v[12:13], v[16:17]
    v_pk_fma_f32 v[18:19], v[78:79], v[14:15], v[18:19]
    v_pk_fma_f32 v[28:29], v[8:9], v[20:21], v[28:29]
    v_pk_fma_f32 v[30:31], v[10:11], v[22:23], v[30:31]
    v_pk_fma_f32 v[32:33], v[16:17], v[20:21], v[32:33]
    v_pk_fma_f32 v[34:35], v[18:19], v[22:23], v[34:35]
    v_mfma_f32_16x16x32_bf16 v[44:47], v[52:55], v[112:115], v[36:39]
    v_exp_f32 v40, v40 clamp
    v_mfma_f32_16x16x32_bf16 v[44:47], v[116:119], v[84:87], v[44:47]
    v_exp_f32 v41, v41 clamp
    v_exp_f32 v42, v42 clamp
    v_exp_f32 v43, v43 clamp
L_m0_4:
    s_sub_u32 s24, s24, 1
    s_cbranch_scc1 L_b0_4
    s_waitcnt lgkmcnt(0)
    buffer_load_dwordx4 v[72:75], v[100:101], s[76:79], 0 idxen offen sc1
    s_mov_b64 exec, s[36:37]
    ds_read2st64_b32 v[52:53], v102 offset0:16 offset1:152
    ds_read2st64_b32 v[54:55], v103 offset0:16 offset1:152
    ds_read_u16 v102, v105 offset:256
    ds_read_u16 v103, v105 offset:260
    s_mov_b64 exec, -1
    ds_read_u16 v98, v104 offset:352
    s_waitcnt vmcnt(4)
    v_pk_fma_f32 v[12:13], v[40:41], s[26:27], s[26:27] op_sel:[0,0,1] op_sel_hi:[1,0,1]
    v_pk_fma_f32 v[14:15], v[42:43], s[26:27], s[26:27] op_sel:[0,0,1] op_sel_hi:[1,0,1]
    v_mfma_f32_16x16x32_bf16 v[40:43], v[48:51], v[112:115], v[36:39]
    v_exp_f32 v44, v44 clamp
    v_mfma_f32_16x16x32_bf16 v[40:43], v[116:119], v[88:91], v[40:43]
    v_exp_f32 v45, v45 clamp
    v_exp_f32 v46, v46 clamp
    v_exp_f32 v47, v47 clamp
L_m0_5:
    s_sub_u32 s24, s24, 1
    s_cbranch_scc1 L_b0_5
    s_waitcnt lgkmcnt(0)
    buffer_load_dwordx4 v[76:79], v[98:99], s[76:79], 0 idxen offen sc1
    s_mov_b64 exec, s[36:37]
    ds_read2st64_b32 v[48:49], v102 offset0:16 offset1:152
    ds_read2st64_b32 v[50:51], v103 offset0:16 offset1:152
    ds_read_u16 v102, v105 offset:288
    ds_read_u16 v103, v105 offset:292
    s_mov_b64 exec, -1
    ds_read_u16 v100, v104 offset:384
    s_waitcnt vmcnt(4)
    v_pk_fma_f32 v[44:45], v[44:45], s[26:27], s[26:27] op_sel:[0,0,1] op_sel_hi:[1,0,1]
    v_pk_fma_f32 v[46:47], v[46:47], s[26:27], s[26:27] op_sel:[0,0,1] op_sel_hi:[1,0,1]
    v_pk_mul_f32 v[16:17], v[44:45], v[80:81]
    v_pk_mul_f32 v[18:19], v[46:47], v[82:83]
    v_pk_add_f32 v[8:9], v[12:13], v[44:45]
    v_pk_add_f32 v[10:11], v[14:15], v[46:47]
    v_pk_fma_f32 v[16:17], v[12:13], v[84:85], v[16:17]
    v_pk_fma_f32 v[18:19], v[14:15], v[86:87], v[18:19]
    v_pk_mul_f32 v[12:13], v[12:13], v[44:45]
    v_pk_mul_f32 v[14:15], v[14:15], v[46:47]
    v_mfma_f32_16x16x32_bf16 v[44:47], v[52:55], v[112:115], v[36:39]
    v_exp_f32 v40, v40 clamp
    v_mfma_f32_16x16x32_bf16 v[44:47], v[116:119], v[92:95], v[44:47]
    v_exp_f32 v41, v41 clamp
    v_exp_f32 v42, v42 clamp
    v_exp_f32 v43, v43 clamp
L_m0_6:
    s_sub_u32 s24, s24, 1
    s_cbranch_scc1 L_b0_6
    s_waitcnt lgkmcnt(0)
    buffer_load_dwordx4 v[80:83], v[100:101], s[76:79], 0 idxen offen sc1
    s_mov_b64 exec, s[36:37]
    ds_read2st64_b32 v[52:53], v102 offset0:16 offset1:152
    ds_read2st64_b32 v[54:55], v103 offset0:16 offset1:152
    ds_read_u16 v102, v105 offset:320
    ds_read_u16 v103, v105 offset:324
    s_mov_b64 exec, -1
    ds_read_u16 v98, v104 offset:416
    s_waitcnt vmcnt(4)
    v_pk_fma_f32 v[40:41], v[40:41], s[26:27], s[26:27] op_sel:[0,0,1] op_sel_hi:[1,0,1]
    v_pk_fma_f32 v[42:43], v[42:43], s[26:27], s[26:27] op_sel:[0,0,1] op_sel_hi:[1,0,1]
    v_pk_mul_f32 v[16:17], v[16:17], v[40:41]
    v_pk_mul_f32 v[18:19], v[18:19], v[42:43]
    v_pk_fma_f32 v[8:9], v[8:9], v[40:41], v[12:13]
    v_pk_fma_f32 v[10:11], v[10:11], v[42:43], v[14:15]
    v_pk_fma_f32 v[16:17], v[88:89], v[12:13], v[16:17]
    v_pk_fma_f32 v[18:19], v[90:91], v[14:15], v[18:19]
    v_pk_mul_f32 v[12:13], v[12:13], v[40:41]
    v_pk_mul_f32 v[14:15], v[14:15], v[42:43]
    v_mfma_f32_16x16x32_bf16 v[40:43], v[48:51], v[112:115], v[36:39]
    v_exp_f32 v44, v44 clamp
    v_mfma_f32_16x16x32_bf16 v[40:43], v[116:119], v[64:67], v[40:43]
    v_exp_f32 v45, v45 clamp
    v_exp_f32 v46, v46 clamp
    v_exp_f32 v47, v47 clamp
L_m0_7:
    s_sub_u32 s24, s24, 1
    s_cbranch_scc1 L_b0_7
    s_waitcnt lgkmcnt(0)
    buffer_load_dwordx4 v[84:87], v[98:99], s[76:79], 0 idxen offen sc1
    s_mov_b64 exec, s[36:37]
    ds_read2st64_b32 v[48:49], v102 offset0:16 offset1:152
    ds_read2st64_b32 v[50:51], v103 offset0:16 offset1:152
    ds_read_u16 v102, v105 offset:352
    ds_read_u16 v103, v105 offset:356
    s_mov_b64 exec, -1
    ds_read_u16 v100, v104 offset:448
    s_waitcnt vmcnt(4)
    v_lshl_add_u64 v[104:105], v[104:105], 0, s[38:39]
    v_pk_fma_f32 v[44:45], v[44:45], s[26:27], s[26:27] op_sel:[0,0,1] op_sel_hi:[1,0,1]
    v_pk_fma_f32 v[46:47], v[46:47], s[26:27], s[26:27] op_sel:[0,0,1] op_sel_hi:[1,0,1]
    v_pk_mul_f32 v[20:21], v[12:13], v[44:45]
    v_pk_mul_f32 v[22:23], v[14:15], v[46:47]
    v_rcp_f32 v20, v20
    v_rcp_f32 v21, v21
    v_rcp_f32 v22, v22
    v_rcp_f32 v23, v23
    v_pk_mul_f32 v[16:17], v[16:17], v[44:45]
    v_pk_mul_f32 v[18:19], v[18:19], v[46:47]
    v_pk_fma_f32 v[8:9], v[8:9], v[44:45], v[12:13]
    v_pk_fma_f32 v[10:11], v[10:11], v[46:47], v[14:15]
    v_pk_fma_f32 v[16:17], v[92:93], v[12:13], v[16:17]
    v_pk_fma_f32 v[18:19], v[94:95], v[14:15], v[18:19]
    v_pk_fma_f32 v[28:29], v[8:9], v[20:21], v[28:29]
    v_pk_fma_f32 v[30:31], v[10:11], v[22:23], v[30:31]
    v_pk_fma_f32 v[32:33], v[16:17], v[20:21], v[32:33]
    v_pk_fma_f32 v[34:35], v[18:19], v[22:23], v[34:35]
    v_mfma_f32_16x16x32_bf16 v[44:47], v[52:55], v[112:115], v[36:39]
    v_exp_f32 v40, v40 clamp
    v_mfma_f32_16x16x32_bf16 v[44:47], v[116:119], v[68:71], v[44:47]
    v_exp_f32 v41, v41 clamp
    v_exp_f32 v42, v42 clamp
    v_exp_f32 v43, v43 clamp
    s_branch L_m0_0
L_b0_0:
    s_waitcnt lgkmcnt(0)
    v_mfma_f32_16x16x32_bf16 v[36:39], v[116:119], v[60:63], v[24:27]
    buffer_load_dwordx4 v[88:91], v[100:101], s[76:79], 0 idxen offen sc1
    s_mov_b64 exec, s[36:37]
    ds_read2st64_b32 v[52:53], v102 offset0:16 offset1:152
    ds_read2st64_b32 v[54:55], v103 offset0:16 offset1:152
    ds_read_u16 v102, v105 offset:128
    ds_read_u16 v103, v105 offset:132
    s_mov_b64 exec, -1
    ds_read_u16 v98, v104 offset:224
    s_waitcnt vmcnt(4)
    s_cmp_lg_u32 s22, 0
    s_cbranch_scc1 L_xlp00
    buffer_load_dwordx2 v[96:97], v109, s[40:43], 0 offen
L_xlp00:
    v_pk_fma_f32 v[12:13], v[40:41], s[26:27], s[26:27] op_sel:[0,0,1] op_sel_hi:[1,0,1]
    v_pk_fma_f32 v[14:15], v[42:43], s[26:27], s[26:27] op_sel:[0,0,1] op_sel_hi:[1,0,1]
    v_pk_fma_f32 v[28:29], v[28:29], v[12:13], 1.0 op_sel_hi:[1,1,0]
    v_pk_fma_f32 v[30:31], v[30:31], v[14:15], 1.0 op_sel_hi:[1,1,0]
    v_pk_fma_f32 v[32:33], v[32:33], v[12:13], v[64:65]
    v_pk_fma_f32 v[34:35], v[34:35], v[14:15], v[66:67]
    v_mfma_f32_16x16x32_bf16 v[40:43], v[48:51], v[112:115], v[36:39]
    v_exp_f32 v44, v44 clamp
    v_mfma_f32_16x16x32_bf16 v[40:43], v[116:119], v[72:75], v[40:43]
    v_exp_f32 v45, v45 clamp
    v_exp_f32 v46, v46 clamp
    v_exp_f32 v47, v47 clamp
    s_waitcnt lgkmcnt(0)
    buffer_load_dwordx4 v[92:95], v[98:99], s[76:79], 0 idxen offen sc1
    s_mov_b64 exec, s[36:37]
    ds_read2st64_b32 v[48:49], v102 offset0:16 offset1:152
    ds_read2st64_b32 v[50:51], v103 offset0:16 offset1:152
    ds_read_u16 v102, v105 offset:160
    ds_read_u16 v103, v105 offset:164
    s_mov_b64 exec, -1
    ds_read_u16 v100, v104 offset:256
    s_waitcnt vmcnt(4)
    v_pk_fma_f32 v[44:45], v[44:45], s[26:27], s[26:27] op_sel:[0,0,1] op_sel_hi:[1,0,1]
    v_pk_fma_f32 v[46:47], v[46:47], s[26:27], s[26:27] op_sel:[0,0,1] op_sel_hi:[1,0,1]
    v_pk_mul_f32 v[32:33], v[32:33], v[44:45]
    v_pk_mul_f32 v[34:35], v[34:35], v[46:47]
    v_pk_fma_f32 v[28:29], v[28:29], v[44:45], v[12:13]
    v_pk_fma_f32 v[30:31], v[30:31], v[46:47], v[14:15]
    v_pk_fma_f32 v[32:33], v[68:69], v[12:13], v[32:33]
    v_pk_fma_f32 v[34:35], v[70:71], v[14:15], v[34:35]
L_ep1:
    v_rcp_f32 v28, v28
    v_rcp_f32 v29, v29
    v_rcp_f32 v30, v30
    v_rcp_f32 v31, v31
    s_cmp_ge_u32 s22, 4
    s_cbranch_scc1 L_bx1
    s_waitcnt vmcnt(1)
L_bx1:
    v_pk_fma_f32 v[32:33], v[32:33], v[28:29], v[56:57]
    v_pk_fma_f32 v[34:35], v[34:35], v[30:31], v[58:59]
    ds_read_b128 v[56:59], v108
    v_max_f32 v32, 0, v32
    v_max_f32 v33, 0, v33
    v_max_f32 v34, 0, v34
    v_max_f32 v35, 0, v35
    v_lshrrev_b64 v[106:107], 16, v[106:107]
    v_mov_b64 v[28:29], s[28:29]
    v_mfma_f32_4x4x4_16b_bf16 v[20:23], v[120:121], v[96:97], v[32:35]
    v_mov_b64 v[30:31], s[28:29]
    v_mad_u32_u16 v108, v106, 16, v122 op_sel:[1,0,0,0]
    v_mov_b64 v[32:33], 0
    v_mov_b64 v[34:35], 0
    ds_read_b128 v[60:63], v108
    v_cvt_pk_bf16_f32 v20, v20, v21
    v_cvt_pk_bf16_f32 v21, v22, v23
    s_mov_b32 s30, s31
    s_mov_b32 s22, s31
    s_mov_b32 s31, s32
    s_mov_b32 s32, s33
    s_mov_b32 s33, 0
    buffer_store_dwordx2 v[20:21], v109, s[60:63], 0 offen sc1
L_ns1:
    v_mad_u32_u16 v109, v106, s35, v123
    s_sub_u32 s24, s30, 2
    s_cbranch_scc1 L_fin
    buffer_load_dwordx2 v[96:97], v109, s[40:43], 0 offen
    s_cmp_lg_u32 s32, 0
    s_cbranch_scc1 L_pt1
    s_setprio 2
    s_cmp_lg_u32 s31, 0
    s_cbranch_scc1 L_pt1
    s_setprio 1
L_pt1:
    v_mov_b32 v12, 1.0
    v_mov_b32 v13, 1.0
    v_mov_b64 v[14:15], v[12:13]
    v_mov_b64 v[16:17], 0
    v_mov_b64 v[18:19], 0
    v_mov_b64 v[8:9], 0
    v_mov_b64 v[10:11], 0
    v_mfma_f32_16x16x32_bf16 v[44:47], v[52:55], v[112:115], v[36:39]
    v_exp_f32 v40, v40 clamp
    v_mfma_f32_16x16x32_bf16 v[44:47], v[116:119], v[76:79], v[44:47]
    v_exp_f32 v41, v41 clamp
    v_exp_f32 v42, v42 clamp
    v_exp_f32 v43, v43 clamp
    s_branch L_m0_2
L_b0_1:
    s_waitcnt lgkmcnt(0)
    v_mfma_f32_16x16x32_bf16 v[36:39], v[116:119], v[60:63], v[24:27]
    buffer_load_dwordx4 v[92:95], v[98:99], s[76:79], 0 idxen offen sc1
    s_mov_b64 exec, s[36:37]
    ds_read2st64_b32 v[48:49], v102 offset0:16 offset1:152
    ds_read2st64_b32 v[50:51], v103 offset0:16 offset1:152
    ds_read_u16 v102, v105 offset:160
    ds_read_u16 v103, v105 offset:164
    s_mov_b64 exec, -1
    ds_read_u16 v100, v104 offset:256
    s_waitcnt vmcnt(4)
    s_cmp_lg_u32 s22, 0
    s_cbranch_scc1 L_xlp11
    buffer_load_dwordx2 v[96:97], v109, s[40:43], 0 offen
L_xlp11:
    v_pk_fma_f32 v[44:45], v[44:45], s[26:27], s[26:27] op_sel:[0,0,1] op_sel_hi:[1,0,1]
    v_pk_fma_f32 v[46:47], v[46:47], s[26:27], s[26:27] op_sel:[0,0,1] op_sel_hi:[1,0,1]
    v_pk_mul_f32 v[16:17], v[44:45], v[64:65]
    v_pk_mul_f32 v[18:19], v[46:47], v[66:67]
    v_pk_add_f32 v[8:9], v[12:13], v[44:45]
    v_pk_add_f32 v[10:11], v[14:15], v[46:47]
    v_pk_fma_f32 v[16:17], v[12:13], v[68:69], v[16:17]
    v_pk_fma_f32 v[18:19], v[14:15], v[70:71], v[18:19]
    v_pk_mul_f32 v[12:13], v[12:13], v[44:45]
    v_pk_mul_f32 v[14:15], v[14:15], v[46:47]
    v_pk_fma_f32 v[28:29], v[28:29], v[12:13], v[8:9]
    v_pk_fma_f32 v[30:31], v[30:31], v[14:15], v[10:11]
    v_pk_fma_f32 v[32:33], v[32:33], v[12:13], v[16:17]
    v_pk_fma_f32 v[34:35], v[34:35], v[14:15], v[18:19]
    v_mfma_f32_16x16x32_bf16 v[44:47], v[52:55], v[112:115], v[36:39]
    v_exp_f32 v40, v40 clamp
    v_mfma_f32_16x16x32_bf16 v[44:47], v[116:119], v[76:79], v[44:47]
    v_exp_f32 v41, v41 clamp
    v_exp_f32 v42, v42 clamp
    v_exp_f32 v43, v43 clamp
    s_waitcnt lgkmcnt(0)
    buffer_load_dwordx4 v[64:67], v[100:101], s[76:79], 0 idxen offen sc1
    s_mov_b64 exec, s[36:37]
    ds_read2st64_b32 v[52:53], v102 offset0:16 offset1:152
    ds_read2st64_b32 v[54:55], v103 offset0:16 offset1:152
    ds_read_u16 v102, v105 offset:192
    ds_read_u16 v103, v105 offset:196
    s_mov_b64 exec, -1
    ds_read_u16 v98, v104 offset:288
    s_waitcnt vmcnt(4)
    v_pk_fma_f32 v[40:41], v[40:41], s[26:27], s[26:27] op_sel:[0,0,1] op_sel_hi:[1,0,1]
    v_pk_fma_f32 v[42:43], v[42:43], s[26:27], s[26:27] op_sel:[0,0,1] op_sel_hi:[1,0,1]
    v_pk_mul_f32 v[32:33], v[32:33], v[40:41]
    v_pk_mul_f32 v[34:35], v[34:35], v[42:43]
    v_pk_fma_f32 v[28:29], v[28:29], v[40:41], v[12:13]
    v_pk_fma_f32 v[30:31], v[30:31], v[42:43], v[14:15]
    v_pk_fma_f32 v[32:33], v[72:73], v[12:13], v[32:33]
    v_pk_fma_f32 v[34:35], v[74:75], v[14:15], v[34:35]
L_ep2:
    v_rcp_f32 v28, v28
    v_rcp_f32 v29, v29
    v_rcp_f32 v30, v30
    v_rcp_f32 v31, v31
    s_cmp_ge_u32 s22, 4
    s_cbranch_scc1 L_bx2
    s_waitcnt vmcnt(1)
L_bx2:
    v_pk_fma_f32 v[32:33], v[32:33], v[28:29], v[56:57]
    v_pk_fma_f32 v[34:35], v[34:35], v[30:31], v[58:59]
    ds_read_b128 v[56:59], v108
    v_max_f32 v32, 0, v32
    v_max_f32 v33, 0, v33
    v_max_f32 v34, 0, v34
    v_max_f32 v35, 0, v35
    v_lshrrev_b64 v[106:107], 16, v[106:107]
    v_mov_b64 v[28:29], s[28:29]
    v_mfma_f32_4x4x4_16b_bf16 v[20:23], v[120:121], v[96:97], v[32:35]
    v_mov_b64 v[30:31], s[28:29]
    v_mad_u32_u16 v108, v106, 16, v122 op_sel:[1,0,0,0]
    v_mov_b64 v[32:33], 0
    v_mov_b64 v[34:35], 0
    ds_read_b128 v[60:63], v108
    v_cvt_pk_bf16_f32 v20, v20, v21
    v_cvt_pk_bf16_f32 v21, v22, v23
    s_mov_b32 s30, s31
    s_mov_b32 s22, s31
    s_mov_b32 s31, s32
    s_mov_b32 s32, s33
    s_mov_b32 s33, 0
    buffer_store_dwordx2 v[20:21], v109, s[60:63], 0 offen sc1
L_ns2:
    v_mad_u32_u16 v109, v106, s35, v123
    s_sub_u32 s24, s30, 2
    s_cbranch_scc1 L_fin
    buffer_load_dwordx2 v[96:97], v109, s[40:43], 0 offen
    s_cmp_lg_u32 s32, 0
    s_cbranch_scc1 L_pt2
    s_setprio 2
    s_cmp_lg_u32 s31, 0
    s_cbranch_scc1 L_pt2
    s_setprio 1
L_pt2:
    v_mov_b32 v12, 1.0
    v_mov_b32 v13, 1.0
    v_mov_b64 v[14:15], v[12:13]
    v_mov_b64 v[16:17], 0
    v_mov_b64 v[18:19], 0
    v_mov_b64 v[8:9], 0
    v_mov_b64 v[10:11], 0
    v_mfma_f32_16x16x32_bf16 v[40:43], v[48:51], v[112:115], v[36:39]
    v_exp_f32 v44, v44 clamp
    v_mfma_f32_16x16x32_bf16 v[40:43], v[116:119], v[80:83], v[40:43]
    v_exp_f32 v45, v45 clamp
    v_exp_f32 v46, v46 clamp
    v_exp_f32 v47, v47 clamp
    s_branch L_m0_3
L_b0_2:
    s_waitcnt lgkmcnt(0)
    v_mfma_f32_16x16x32_bf16 v[36:39], v[116:119], v[60:63], v[24:27]
    buffer_load_dwordx4 v[64:67], v[100:101], s[76:79], 0 idxen offen sc1
    s_mov_b64 exec, s[36:37]
    ds_read2st64_b32 v[52:53], v102 offset0:16 offset1:152
    ds_read2st64_b32 v[54:55], v103 offset0:16 offset1:152
    ds_read_u16 v102, v105 offset:192
    ds_read_u16 v103, v105 offset:196
    s_mov_b64 exec, -1
    ds_read_u16 v98, v104 offset:288
    s_waitcnt vmcnt(4)
    s_cmp_lg_u32 s22, 0
    s_cbranch_scc1 L_xlp22
    buffer_load_dwordx2 v[96:97], v109, s[40:43], 0 offen
L_xlp22:
    v_pk_fma_f32 v[40:41], v[40:41], s[26:27], s[26:27] op_sel:[0,0,1] op_sel_hi:[1,0,1]
    v_pk_fma_f32 v[42:43], v[42:43], s[26:27], s[26:27] op_sel:[0,0,1] op_sel_hi:[1,0,1]
    v_pk_mul_f32 v[16:17], v[16:17], v[40:41]
    v_pk_mul_f32 v[18:19], v[18:19], v[42:43]
    v_pk_fma_f32 v[8:9], v[8:9], v[40:41], v[12:13]
    v_pk_fma_f32 v[10:11], v[10:11], v[42:43], v[14:15]
    v_pk_fma_f32 v[16:17], v[72:73], v[12:13], v[16:17]
    v_pk_fma_f32 v[18:19], v[74:75], v[14:15], v[18:19]
    v_pk_mul_f32 v[12:13], v[12:13], v[40:41]
    v_pk_mul_f32 v[14:15], v[14:15], v[42:43]
    v_pk_fma_f32 v[28:29], v[28:29], v[12:13], v[8:9]
    v_pk_fma_f32 v[30:31], v[30:31], v[14:15], v[10:11]
    v_pk_fma_f32 v[32:33], v[32:33], v[12:13], v[16:17]
    v_pk_fma_f32 v[34:35], v[34:35], v[14:15], v[18:19]
    v_mfma_f32_16x16x32_bf16 v[40:43], v[48:51], v[112:115], v[36:39]
    v_exp_f32 v44, v44 clamp
    v_mfma_f32_16x16x32_bf16 v[40:43], v[116:119], v[80:83], v[40:43]
    v_exp_f32 v45, v45 clamp
    v_exp_f32 v46, v46 clamp
    v_exp_f32 v47, v47 clamp
    s_waitcnt lgkmcnt(0)
    buffer_load_dwordx4 v[68:71], v[98:99], s[76:79], 0 idxen offen sc1
    s_mov_b64 exec, s[36:37]
    ds_read2st64_b32 v[48:49], v102 offset0:16 offset1:152
    ds_read2st64_b32 v[50:51], v103 offset0:16 offset1:152
    ds_read_u16 v102, v105 offset:224
    ds_read_u16 v103, v105 offset:228
    s_mov_b64 exec, -1
    ds_read_u16 v100, v104 offset:320
    s_waitcnt vmcnt(4)
    v_pk_fma_f32 v[44:45], v[44:45], s[26:27], s[26:27] op_sel:[0,0,1] op_sel_hi:[1,0,1]
    v_pk_fma_f32 v[46:47], v[46:47], s[26:27], s[26:27] op_sel:[0,0,1] op_sel_hi:[1,0,1]
    v_pk_mul_f32 v[32:33], v[32:33], v[44:45]
    v_pk_mul_f32 v[34:35], v[34:35], v[46:47]
    v_pk_fma_f32 v[28:29], v[28:29], v[44:45], v[12:13]
    v_pk_fma_f32 v[30:31], v[30:31], v[46:47], v[14:15]
    v_pk_fma_f32 v[32:33], v[76:77], v[12:13], v[32:33]
    v_pk_fma_f32 v[34:35], v[78:79], v[14:15], v[34:35]
L_ep3:
    v_rcp_f32 v28, v28
    v_rcp_f32 v29, v29
    v_rcp_f32 v30, v30
    v_rcp_f32 v31, v31
    s_cmp_ge_u32 s22, 4
    s_cbranch_scc1 L_bx3
    s_waitcnt vmcnt(1)
L_bx3:
    v_pk_fma_f32 v[32:33], v[32:33], v[28:29], v[56:57]
    v_pk_fma_f32 v[34:35], v[34:35], v[30:31], v[58:59]
    ds_read_b128 v[56:59], v108
    v_max_f32 v32, 0, v32
    v_max_f32 v33, 0, v33
    v_max_f32 v34, 0, v34
    v_max_f32 v35, 0, v35
    v_lshrrev_b64 v[106:107], 16, v[106:107]
    v_mov_b64 v[28:29], s[28:29]
    v_mfma_f32_4x4x4_16b_bf16 v[20:23], v[120:121], v[96:97], v[32:35]
    v_mov_b64 v[30:31], s[28:29]
    v_mad_u32_u16 v108, v106, 16, v122 op_sel:[1,0,0,0]
    v_mov_b64 v[32:33], 0
    v_mov_b64 v[34:35], 0
    ds_read_b128 v[60:63], v108
    v_cvt_pk_bf16_f32 v20, v20, v21
    v_cvt_pk_bf16_f32 v21, v22, v23
    s_mov_b32 s30, s31
    s_mov_b32 s22, s31
    s_mov_b32 s31, s32
    s_mov_b32 s32, s33
    s_mov_b32 s33, 0
    buffer_store_dwordx2 v[20:21], v109, s[60:63], 0 offen sc1
L_ns3:
    v_mad_u32_u16 v109, v106, s35, v123
    s_sub_u32 s24, s30, 2
    s_cbranch_scc1 L_fin
    buffer_load_dwordx2 v[96:97], v109, s[40:43], 0 offen
    s_cmp_lg_u32 s32, 0
    s_cbranch_scc1 L_pt3
    s_setprio 2
    s_cmp_lg_u32 s31, 0
    s_cbranch_scc1 L_pt3
    s_setprio 1
L_pt3:
    v_mfma_f32_16x16x32_bf16 v[44:47], v[52:55], v[112:115], v[36:39]
    v_exp_f32 v40, v40 clamp
    v_mfma_f32_16x16x32_bf16 v[44:47], v[116:119], v[84:87], v[44:47]
    v_exp_f32 v41, v41 clamp
    v_exp_f32 v42, v42 clamp
    v_exp_f32 v43, v43 clamp
    s_branch L_m0_4
L_b0_3:
    s_waitcnt lgkmcnt(0)
    v_mfma_f32_16x16x32_bf16 v[36:39], v[116:119], v[60:63], v[24:27]
    buffer_load_dwordx4 v[68:71], v[98:99], s[76:79], 0 idxen offen sc1
    s_mov_b64 exec, s[36:37]
    ds_read2st64_b32 v[48:49], v102 offset0:16 offset1:152
    ds_read2st64_b32 v[50:51], v103 offset0:16 offset1:152
    ds_read_u16 v102, v105 offset:224
    ds_read_u16 v103, v105 offset:228
    s_mov_b64 exec, -1
    ds_read_u16 v100, v104 offset:320
    s_waitcnt vmcnt(4)
    s_cmp_lg_u32 s22, 0
    s_cbranch_scc1 L_xlp33
    buffer_load_dwordx2 v[96:97], v109, s[40:43], 0 offen
L_xlp33:
    v_pk_fma_f32 v[44:45], v[44:45], s[26:27], s[26:27] op_sel:[0,0,1] op_sel_hi:[1,0,1]
    v_pk_fma_f32 v[46:47], v[46:47], s[26:27], s[26:27] op_sel:[0,0,1] op_sel_hi:[1,0,1]
    v_pk_mul_f32 v[20:21], v[12:13], v[44:45]
    v_pk_mul_f32 v[22:23], v[14:15], v[46:47]
    v_rcp_f32 v20, v20
    v_rcp_f32 v21, v21
    v_rcp_f32 v22, v22
    v_rcp_f32 v23, v23
    v_pk_mul_f32 v[16:17], v[16:17], v[44:45]
    v_pk_mul_f32 v[18:19], v[18:19], v[46:47]
    v_pk_fma_f32 v[8:9], v[8:9], v[44:45], v[12:13]
    v_pk_fma_f32 v[10:11], v[10:11], v[46:47], v[14:15]
    v_pk_fma_f32 v[16:17], v[76:77], v[12:13], v[16:17]
    v_pk_fma_f32 v[18:19], v[78:79], v[14:15], v[18:19]
    v_pk_fma_f32 v[28:29], v[8:9], v[20:21], v[28:29]
    v_pk_fma_f32 v[30:31], v[10:11], v[22:23], v[30:31]
    v_pk_fma_f32 v[32:33], v[16:17], v[20:21], v[32:33]
    v_pk_fma_f32 v[34:35], v[18:19], v[22:23], v[34:35]
    v_mfma_f32_16x16x32_bf16 v[44:47], v[52:55], v[112:115], v[36:39]
    v_exp_f32 v40, v40 clamp
    v_mfma_f32_16x16x32_bf16 v[44:47], v[116:119], v[84:87], v[44:47]
    v_exp_f32 v41, v41 clamp
    v_exp_f32 v42, v42 clamp
    v_exp_f32 v43, v43 clamp
    s_waitcnt lgkmcnt(0)
    buffer_load_dwordx4 v[72:75], v[100:101], s[76:79], 0 idxen offen sc1
    s_mov_b64 exec, s[36:37]
    ds_read2st64_b32 v[52:53], v102 offset0:16 offset1:152
    ds_read2st64_b32 v[54:55], v103 offset0:16 offset1:152
    ds_read_u16 v102, v105 offset:256
    ds_read_u16 v103, v105 offset:260
    s_mov_b64 exec, -1
    ds_read_u16 v98, v104 offset:352
    s_waitcnt vmcnt(4)
    v_pk_fma_f32 v[40:41], v[40:41], s[26:27], s[26:27] op_sel:[0,0,1] op_sel_hi:[1,0,1]
    v_pk_fma_f32 v[42:43], v[42:43], s[26:27], s[26:27] op_sel:[0,0,1] op_sel_hi:[1,0,1]
    v_pk_fma_f32 v[28:29], v[28:29], v[40:41], 1.0 op_sel_hi:[1,1,0]
    v_pk_fma_f32 v[30:31], v[30:31], v[42:43], 1.0 op_sel_hi:[1,1,0]
    v_pk_fma_f32 v[32:33], v[32:33], v[40:41], v[80:81]
    v_pk_fma_f32 v[34:35], v[34:35], v[42:43], v[82:83]
L_ep4:
    v_rcp_f32 v28, v28
    v_rcp_f32 v29, v29
    v_rcp_f32 v30, v30
    v_rcp_f32 v31, v31
    s_cmp_ge_u32 s22, 4
    s_cbranch_scc1 L_bx4
    s_waitcnt vmcnt(1)
L_bx4:
    v_pk_fma_f32 v[32:33], v[32:33], v[28:29], v[56:57]
    v_pk_fma_f32 v[34:35], v[34:35], v[30:31], v[58:59]
    ds_read_b128 v[56:59], v108
    v_max_f32 v32, 0, v32
    v_max_f32 v33, 0, v33
    v_max_f32 v34, 0, v34
    v_max_f32 v35, 0, v35
    v_lshrrev_b64 v[106:107], 16, v[106:107]
    v_mov_b64 v[28:29], s[28:29]
    v_mfma_f32_4x4x4_16b_bf16 v[20:23], v[120:121], v[96:97], v[32:35]
    v_mov_b64 v[30:31], s[28:29]
    v_mad_u32_u16 v108, v106, 16, v122 op_sel:[1,0,0,0]
    v_mov_b64 v[32:33], 0
    v_mov_b64 v[34:35], 0
    ds_read_b128 v[60:63], v108
    v_cvt_pk_bf16_f32 v20, v20, v21
    v_cvt_pk_bf16_f32 v21, v22, v23
    s_mov_b32 s30, s31
    s_mov_b32 s22, s31
    s_mov_b32 s31, s32
    s_mov_b32 s32, s33
    s_mov_b32 s33, 0
    buffer_store_dwordx2 v[20:21], v109, s[60:63], 0 offen sc1
L_ns4:
    v_mad_u32_u16 v109, v106, s35, v123
    s_sub_u32 s24, s30, 2
    s_cbranch_scc1 L_fin
    buffer_load_dwordx2 v[96:97], v109, s[40:43], 0 offen
    s_cmp_lg_u32 s32, 0
    s_cbranch_scc1 L_pt4
    s_setprio 2
    s_cmp_lg_u32 s31, 0
    s_cbranch_scc1 L_pt4
    s_setprio 1
L_pt4:
    v_mov_b32 v12, 0x51000000
    v_mov_b32 v13, v12
    v_mov_b64 v[14:15], v[12:13]
    v_mov_b64 v[80:81], 0
    v_mov_b64 v[82:83], 0
    v_mfma_f32_16x16x32_bf16 v[40:43], v[48:51], v[112:115], v[36:39]
    v_exp_f32 v44, v44 clamp
    v_mfma_f32_16x16x32_bf16 v[40:43], v[116:119], v[88:91], v[40:43]
    v_exp_f32 v45, v45 clamp
    v_exp_f32 v46, v46 clamp
    v_exp_f32 v47, v47 clamp
    s_branch L_m0_5
L_b0_4:
    s_waitcnt lgkmcnt(0)
    v_mfma_f32_16x16x32_bf16 v[36:39], v[116:119], v[60:63], v[24:27]
    buffer_load_dwordx4 v[72:75], v[100:101], s[76:79], 0 idxen offen sc1
    s_mov_b64 exec, s[36:37]
    ds_read2st64_b32 v[52:53], v102 offset0:16 offset1:152
    ds_read2st64_b32 v[54:55], v103 offset0:16 offset1:152
    ds_read_u16 v102, v105 offset:256
    ds_read_u16 v103, v105 offset:260
    s_mov_b64 exec, -1
    ds_read_u16 v98, v104 offset:352
    s_waitcnt vmcnt(4)
    s_cmp_lg_u32 s22, 0
    s_cbranch_scc1 L_xlp04
    buffer_load_dwordx2 v[96:97], v109, s[40:43], 0 offen
L_xlp04:
    v_pk_fma_f32 v[12:13], v[40:41], s[26:27], s[26:27] op_sel:[0,0,1] op_sel_hi:[1,0,1]
    v_pk_fma_f32 v[14:15], v[42:43], s[26:27], s[26:27] op_sel:[0,0,1] op_sel_hi:[1,0,1]
    v_pk_fma_f32 v[28:29], v[28:29], v[12:13], 1.0 op_sel_hi:[1,1,0]
    v_pk_fma_f32 v[30:31], v[30:31], v[14:15], 1.0 op_sel_hi:[1,1,0]
    v_pk_fma_f32 v[32:33], v[32:33], v[12:13], v[80:81]
    v_pk_fma_f32 v[34:35], v[34:35], v[14:15], v[82:83]
    v_mfma_f32_16x16x32_bf16 v[40:43], v[48:51], v[112:115], v[36:39]
    v_exp_f32 v44, v44 clamp
    v_mfma_f32_16x16x32_bf16 v[40:43], v[116:119], v[88:91], v[40:43]
    v_exp_f32 v45, v45 clamp
    v_exp_f32 v46, v46 clamp
    v_exp_f32 v47, v47 clamp
    s_waitcnt lgkmcnt(0)
    buffer_load_dwordx4 v[76:79], v[98:99], s[76:79], 0 idxen offen sc1
    s_mov_b64 exec, s[36:37]
    ds_read2st64_b32 v[48:49], v102 offset0:16 offset1:152
    ds_read2st64_b32 v[50:51], v103 offset0:16 offset1:152
    ds_read_u16 v102, v105 offset:288
    ds_read_u16 v103, v105 offset:292
    s_mov_b64 exec, -1
    ds_read_u16 v100, v104 offset:384
    s_waitcnt vmcnt(4)
    v_pk_fma_f32 v[44:45], v[44:45], s[26:27], s[26:27] op_sel:[0,0,1] op_sel_hi:[1,0,1]
    v_pk_fma_f32 v[46:47], v[46:47], s[26:27], s[26:27] op_sel:[0,0,1] op_sel_hi:[1,0,1]
    v_pk_mul_f32 v[32:33], v[32:33], v[44:45]
    v_pk_mul_f32 v[34:35], v[34:35], v[46:47]
    v_pk_fma_f32 v[28:29], v[28:29], v[44:45], v[12:13]
    v_pk_fma_f32 v[30:31], v[30:31], v[46:47], v[14:15]
    v_pk_fma_f32 v[32:33], v[84:85], v[12:13], v[32:33]
    v_pk_fma_f32 v[34:35], v[86:87], v[14:15], v[34:35]
L_ep5:
    v_rcp_f32 v28, v28
    v_rcp_f32 v29, v29
    v_rcp_f32 v30, v30
    v_rcp_f32 v31, v31
    s_cmp_ge_u32 s22, 4
    s_cbranch_scc1 L_bx5
    s_waitcnt vmcnt(1)
L_bx5:
    v_pk_fma_f32 v[32:33], v[32:33], v[28:29], v[56:57]
    v_pk_fma_f32 v[34:35], v[34:35], v[30:31], v[58:59]
    ds_read_b128 v[56:59], v108
    v_max_f32 v32, 0, v32
    v_max_f32 v33, 0, v33
    v_max_f32 v34, 0, v34
    v_max_f32 v35, 0, v35
    v_lshrrev_b64 v[106:107], 16, v[106:107]
    v_mov_b64 v[28:29], s[28:29]
    v_mfma_f32_4x4x4_16b_bf16 v[20:23], v[120:121], v[96:97], v[32:35]
    v_mov_b64 v[30:31], s[28:29]
    v_mad_u32_u16 v108, v106, 16, v122 op_sel:[1,0,0,0]
    v_mov_b64 v[32:33], 0
    v_mov_b64 v[34:35], 0
    ds_read_b128 v[60:63], v108
    v_cvt_pk_bf16_f32 v20, v20, v21
    v_cvt_pk_bf16_f32 v21, v22, v23
    s_mov_b32 s30, s31
    s_mov_b32 s22, s31
    s_mov_b32 s31, s32
    s_mov_b32 s32, s33
    s_mov_b32 s33, 0
    buffer_store_dwordx2 v[20:21], v109, s[60:63], 0 offen sc1
L_ns5:
    v_mad_u32_u16 v109, v106, s35, v123
    s_sub_u32 s24, s30, 2
    s_cbranch_scc1 L_fin
    buffer_load_dwordx2 v[96:97], v109, s[40:43], 0 offen
    s_cmp_lg_u32 s32, 0
    s_cbranch_scc1 L_pt5
    s_setprio 2
    s_cmp_lg_u32 s31, 0
    s_cbranch_scc1 L_pt5
    s_setprio 1
L_pt5:
    v_mov_b32 v12, 1.0
    v_mov_b32 v13, 1.0
    v_mov_b64 v[14:15], v[12:13]
    v_mov_b64 v[16:17], 0
    v_mov_b64 v[18:19], 0
    v_mov_b64 v[8:9], 0
    v_mov_b64 v[10:11], 0
    v_mfma_f32_16x16x32_bf16 v[44:47], v[52:55], v[112:115], v[36:39]
    v_exp_f32 v40, v40 clamp
    v_mfma_f32_16x16x32_bf16 v[44:47], v[116:119], v[92:95], v[44:47]
    v_exp_f32 v41, v41 clamp
    v_exp_f32 v42, v42 clamp
    v_exp_f32 v43, v43 clamp
    s_branch L_m0_6
L_b0_5:
    s_waitcnt lgkmcnt(0)
    v_mfma_f32_16x16x32_bf16 v[36:39], v[116:119], v[60:63], v[24:27]
    buffer_load_dwordx4 v[76:79], v[98:99], s[76:79], 0 idxen offen sc1
    s_mov_b64 exec, s[36:37]
    ds_read2st64_b32 v[48:49], v102 offset0:16 offset1:152
    ds_read2st64_b32 v[50:51], v103 offset0:16 offset1:152
    ds_read_u16 v102, v105 offset:288
    ds_read_u16 v103, v105 offset:292
    s_mov_b64 exec, -1
    ds_read_u16 v100, v104 offset:384
    s_waitcnt vmcnt(4)
    s_cmp_lg_u32 s22, 0
    s_cbranch_scc1 L_xlp15
    buffer_load_dwordx2 v[96:97], v109, s[40:43], 0 offen
L_xlp15:
    v_pk_fma_f32 v[44:45], v[44:45], s[26:27], s[26:27] op_sel:[0,0,1] op_sel_hi:[1,0,1]
    v_pk_fma_f32 v[46:47], v[46:47], s[26:27], s[26:27] op_sel:[0,0,1] op_sel_hi:[1,0,1]
    v_pk_mul_f32 v[16:17], v[44:45], v[80:81]
    v_pk_mul_f32 v[18:19], v[46:47], v[82:83]
    v_pk_add_f32 v[8:9], v[12:13], v[44:45]
    v_pk_add_f32 v[10:11], v[14:15], v[46:47]
    v_pk_fma_f32 v[16:17], v[12:13], v[84:85], v[16:17]
    v_pk_fma_f32 v[18:19], v[14:15], v[86:87], v[18:19]
    v_pk_mul_f32 v[12:13], v[12:13], v[44:45]
    v_pk_mul_f32 v[14:15], v[14:15], v[46:47]
    v_pk_fma_f32 v[28:29], v[28:29], v[12:13], v[8:9]
    v_pk_fma_f32 v[30:31], v[30:31], v[14:15], v[10:11]
    v_pk_fma_f32 v[32:33], v[32:33], v[12:13], v[16:17]
    v_pk_fma_f32 v[34:35], v[34:35], v[14:15], v[18:19]
    v_mfma_f32_16x16x32_bf16 v[44:47], v[52:55], v[112:115], v[36:39]
    v_exp_f32 v40, v40 clamp
    v_mfma_f32_16x16x32_bf16 v[44:47], v[116:119], v[92:95], v[44:47]
    v_exp_f32 v41, v41 clamp
    v_exp_f32 v42, v42 clamp
    v_exp_f32 v43, v43 clamp
    s_waitcnt lgkmcnt(0)
    buffer_load_dwordx4 v[80:83], v[100:101], s[76:79], 0 idxen offen sc1
    s_mov_b64 exec, s[36:37]
    ds_read2st64_b32 v[52:53], v102 offset0:16 offset1:152
    ds_read2st64_b32 v[54:55], v103 offset0:16 offset1:152
    ds_read_u16 v102, v105 offset:320
    ds_read_u16 v103, v105 offset:324
    s_mov_b64 exec, -1
    ds_read_u16 v98, v104 offset:416
    s_waitcnt vmcnt(4)
    v_pk_fma_f32 v[40:41], v[40:41], s[26:27], s[26:27] op_sel:[0,0,1] op_sel_hi:[1,0,1]
    v_pk_fma_f32 v[42:43], v[42:43], s[26:27], s[26:27] op_sel:[0,0,1] op_sel_hi:[1,0,1]
    v_pk_mul_f32 v[32:33], v[32:33], v[40:41]
    v_pk_mul_f32 v[34:35], v[34:35], v[42:43]
    v_pk_fma_f32 v[28:29], v[28:29], v[40:41], v[12:13]
    v_pk_fma_f32 v[30:31], v[30:31], v[42:43], v[14:15]
    v_pk_fma_f32 v[32:33], v[88:89], v[12:13], v[32:33]
    v_pk_fma_f32 v[34:35], v[90:91], v[14:15], v[34:35]
L_ep6:
    v_rcp_f32 v28, v28
    v_rcp_f32 v29, v29
    v_rcp_f32 v30, v30
    v_rcp_f32 v31, v31
    s_cmp_ge_u32 s22, 4
    s_cbranch_scc1 L_bx6
    s_waitcnt vmcnt(1)
L_bx6:
    v_pk_fma_f32 v[32:33], v[32:33], v[28:29], v[56:57]
    v_pk_fma_f32 v[34:35], v[34:35], v[30:31], v[58:59]
    ds_read_b128 v[56:59], v108
    v_max_f32 v32, 0, v32
    v_max_f32 v33, 0, v33
    v_max_f32 v34, 0, v34
    v_max_f32 v35, 0, v35
    v_lshrrev_b64 v[106:107], 16, v[106:107]
    v_mov_b64 v[28:29], s[28:29]
    v_mfma_f32_4x4x4_16b_bf16 v[20:23], v[120:121], v[96:97], v[32:35]
    v_mov_b64 v[30:31], s[28:29]
    v_mad_u32_u16 v108, v106, 16, v122 op_sel:[1,0,0,0]
    v_mov_b64 v[32:33], 0
    v_mov_b64 v[34:35], 0
    ds_read_b128 v[60:63], v108
    v_cvt_pk_bf16_f32 v20, v20, v21
    v_cvt_pk_bf16_f32 v21, v22, v23
    s_mov_b32 s30, s31
    s_mov_b32 s22, s31
    s_mov_b32 s31, s32
    s_mov_b32 s32, s33
    s_mov_b32 s33, 0
    buffer_store_dwordx2 v[20:21], v109, s[60:63], 0 offen sc1
L_ns6:
    v_mad_u32_u16 v109, v106, s35, v123
    s_sub_u32 s24, s30, 2
    s_cbranch_scc1 L_fin
    buffer_load_dwordx2 v[96:97], v109, s[40:43], 0 offen
    s_cmp_lg_u32 s32, 0
    s_cbranch_scc1 L_pt6
    s_setprio 2
    s_cmp_lg_u32 s31, 0
    s_cbranch_scc1 L_pt6
    s_setprio 1
L_pt6:
    v_mov_b32 v12, 1.0
    v_mov_b32 v13, 1.0
    v_mov_b64 v[14:15], v[12:13]
    v_mov_b64 v[16:17], 0
    v_mov_b64 v[18:19], 0
    v_mov_b64 v[8:9], 0
    v_mov_b64 v[10:11], 0
    v_mfma_f32_16x16x32_bf16 v[40:43], v[48:51], v[112:115], v[36:39]
    v_exp_f32 v44, v44 clamp
    v_mfma_f32_16x16x32_bf16 v[40:43], v[116:119], v[64:67], v[40:43]
    v_exp_f32 v45, v45 clamp
    v_exp_f32 v46, v46 clamp
    v_exp_f32 v47, v47 clamp
    s_branch L_m0_7
L_b0_6:
    s_waitcnt lgkmcnt(0)
    v_mfma_f32_16x16x32_bf16 v[36:39], v[116:119], v[60:63], v[24:27]
    buffer_load_dwordx4 v[80:83], v[100:101], s[76:79], 0 idxen offen sc1
    s_mov_b64 exec, s[36:37]
    ds_read2st64_b32 v[52:53], v102 offset0:16 offset1:152
    ds_read2st64_b32 v[54:55], v103 offset0:16 offset1:152
    ds_read_u16 v102, v105 offset:320
    ds_read_u16 v103, v105 offset:324
    s_mov_b64 exec, -1
    ds_read_u16 v98, v104 offset:416
    s_waitcnt vmcnt(4)
    s_cmp_lg_u32 s22, 0
    s_cbranch_scc1 L_xlp26
    buffer_load_dwordx2 v[96:97], v109, s[40:43], 0 offen
L_xlp26:
    v_pk_fma_f32 v[40:41], v[40:41], s[26:27], s[26:27] op_sel:[0,0,1] op_sel_hi:[1,0,1]
    v_pk_fma_f32 v[42:43], v[42:43], s[26:27], s[26:27] op_sel:[0,0,1] op_sel_hi:[1,0,1]
    v_pk_mul_f32 v[16:17], v[16:17], v[40:41]
    v_pk_mul_f32 v[18:19], v[18:19], v[42:43]
    v_pk_fma_f32 v[8:9], v[8:9], v[40:41], v[12:13]
    v_pk_fma_f32 v[10:11], v[10:11], v[42:43], v[14:15]
    v_pk_fma_f32 v[16:17], v[88:89], v[12:13], v[16:17]
    v_pk_fma_f32 v[18:19], v[90:91], v[14:15], v[18:19]
    v_pk_mul_f32 v[12:13], v[12:13], v[40:41]
    v_pk_mul_f32 v[14:15], v[14:15], v[42:43]
    v_pk_fma_f32 v[28:29], v[28:29], v[12:13], v[8:9]
    v_pk_fma_f32 v[30:31], v[30:31], v[14:15], v[10:11]
    v_pk_fma_f32 v[32:33], v[32:33], v[12:13], v[16:17]
    v_pk_fma_f32 v[34:35], v[34:35], v[14:15], v[18:19]
    v_mfma_f32_16x16x32_bf16 v[40:43], v[48:51], v[112:115], v[36:39]
    v_exp_f32 v44, v44 clamp
    v_mfma_f32_16x16x32_bf16 v[40:43], v[116:119], v[64:67], v[40:43]
    v_exp_f32 v45, v45 clamp
    v_exp_f32 v46, v46 clamp
    v_exp_f32 v47, v47 clamp
    s_waitcnt lgkmcnt(0)
    buffer_load_dwordx4 v[84:87], v[98:99], s[76:79], 0 idxen offen sc1
    s_mov_b64 exec, s[36:37]
    ds_read2st64_b32 v[48:49], v102 offset0:16 offset1:152
    ds_read2st64_b32 v[50:51], v103 offset0:16 offset1:152
    ds_read_u16 v102, v105 offset:352
    ds_read_u16 v103, v105 offset:356
    s_mov_b64 exec, -1
    ds_read_u16 v100, v104 offset:448
    s_waitcnt vmcnt(4)
    v_lshl_add_u64 v[104:105], v[104:105], 0, s[38:39]
    v_pk_fma_f32 v[44:45], v[44:45], s[26:27], s[26:27] op_sel:[0,0,1] op_sel_hi:[1,0,1]
    v_pk_fma_f32 v[46:47], v[46:47], s[26:27], s[26:27] op_sel:[0,0,1] op_sel_hi:[1,0,1]
    v_pk_mul_f32 v[32:33], v[32:33], v[44:45]
    v_pk_mul_f32 v[34:35], v[34:35], v[46:47]
    v_pk_fma_f32 v[28:29], v[28:29], v[44:45], v[12:13]
    v_pk_fma_f32 v[30:31], v[30:31], v[46:47], v[14:15]
    v_pk_fma_f32 v[32:33], v[92:93], v[12:13], v[32:33]
    v_pk_fma_f32 v[34:35], v[94:95], v[14:15], v[34:35]
L_ep7:
    v_rcp_f32 v28, v28
    v_rcp_f32 v29, v29
    v_rcp_f32 v30, v30
    v_rcp_f32 v31, v31
    s_cmp_ge_u32 s22, 4
    s_cbranch_scc1 L_bx7
    s_waitcnt vmcnt(1)
L_bx7:
    v_pk_fma_f32 v[32:33], v[32:33], v[28:29], v[56:57]
    v_pk_fma_f32 v[34:35], v[34:35], v[30:31], v[58:59]
    ds_read_b128 v[56:59], v108
    v_max_f32 v32, 0, v32
    v_max_f32 v33, 0, v33
    v_max_f32 v34, 0, v34
    v_max_f32 v35, 0, v35
    v_lshrrev_b64 v[106:107], 16, v[106:107]
    v_mov_b64 v[28:29], s[28:29]
    v_mfma_f32_4x4x4_16b_bf16 v[20:23], v[120:121], v[96:97], v[32:35]
    v_mov_b64 v[30:31], s[28:29]
    v_mad_u32_u16 v108, v106, 16, v122 op_sel:[1,0,0,0]
    v_mov_b64 v[32:33], 0
    v_mov_b64 v[34:35], 0
    ds_read_b128 v[60:63], v108
    v_cvt_pk_bf16_f32 v20, v20, v21
    v_cvt_pk_bf16_f32 v21, v22, v23
    s_mov_b32 s30, s31
    s_mov_b32 s22, s31
    s_mov_b32 s31, s32
    s_mov_b32 s32, s33
    s_mov_b32 s33, 0
    buffer_store_dwordx2 v[20:21], v109, s[60:63], 0 offen sc1
L_ns7:
    v_mad_u32_u16 v109, v106, s35, v123
    s_sub_u32 s24, s30, 2
    s_cbranch_scc1 L_fin
    buffer_load_dwordx2 v[96:97], v109, s[40:43], 0 offen
    s_cmp_lg_u32 s32, 0
    s_cbranch_scc1 L_pt7
    s_setprio 2
    s_cmp_lg_u32 s31, 0
    s_cbranch_scc1 L_pt7
    s_setprio 1
L_pt7:
    v_mfma_f32_16x16x32_bf16 v[44:47], v[52:55], v[112:115], v[36:39]
    v_exp_f32 v40, v40 clamp
    v_mfma_f32_16x16x32_bf16 v[44:47], v[116:119], v[68:71], v[44:47]
    v_exp_f32 v41, v41 clamp
    v_exp_f32 v42, v42 clamp
    v_exp_f32 v43, v43 clamp
    s_branch L_m0_0
L_b0_7:
    s_waitcnt lgkmcnt(0)
    v_mfma_f32_16x16x32_bf16 v[36:39], v[116:119], v[60:63], v[24:27]
    buffer_load_dwordx4 v[84:87], v[98:99], s[76:79], 0 idxen offen sc1
    s_mov_b64 exec, s[36:37]
    ds_read2st64_b32 v[48:49], v102 offset0:16 offset1:152
    ds_read2st64_b32 v[50:51], v103 offset0:16 offset1:152
    ds_read_u16 v102, v105 offset:352
    ds_read_u16 v103, v105 offset:356
    s_mov_b64 exec, -1
    ds_read_u16 v100, v104 offset:448
    s_waitcnt vmcnt(4)
    s_cmp_lg_u32 s22, 0
    s_cbranch_scc1 L_xlp37
    buffer_load_dwordx2 v[96:97], v109, s[40:43], 0 offen
L_xlp37:
    v_lshl_add_u64 v[104:105], v[104:105], 0, s[38:39]
    v_pk_fma_f32 v[44:45], v[44:45], s[26:27], s[26:27] op_sel:[0,0,1] op_sel_hi:[1,0,1]
    v_pk_fma_f32 v[46:47], v[46:47], s[26:27], s[26:27] op_sel:[0,0,1] op_sel_hi:[1,0,1]
    v_pk_mul_f32 v[20:21], v[12:13], v[44:45]
    v_pk_mul_f32 v[22:23], v[14:15], v[46:47]
    v_rcp_f32 v20, v20
    v_rcp_f32 v21, v21
    v_rcp_f32 v22, v22
    v_rcp_f32 v23, v23
    v_pk_mul_f32 v[16:17], v[16:17], v[44:45]
    v_pk_mul_f32 v[18:19], v[18:19], v[46:47]
    v_pk_fma_f32 v[8:9], v[8:9], v[44:45], v[12:13]
    v_pk_fma_f32 v[10:11], v[10:11], v[46:47], v[14:15]
    v_pk_fma_f32 v[16:17], v[92:93], v[12:13], v[16:17]
    v_pk_fma_f32 v[18:19], v[94:95], v[14:15], v[18:19]
    v_pk_fma_f32 v[28:29], v[8:9], v[20:21], v[28:29]
    v_pk_fma_f32 v[30:31], v[10:11], v[22:23], v[30:31]
    v_pk_fma_f32 v[32:33], v[16:17], v[20:21], v[32:33]
    v_pk_fma_f32 v[34:35], v[18:19], v[22:23], v[34:35]
    v_mfma_f32_16x16x32_bf16 v[44:47], v[52:55], v[112:115], v[36:39]
    v_exp_f32 v40, v40 clamp
    v_mfma_f32_16x16x32_bf16 v[44:47], v[116:119], v[68:71], v[44:47]
    v_exp_f32 v41, v41 clamp
    v_exp_f32 v42, v42 clamp
    v_exp_f32 v43, v43 clamp
    s_waitcnt lgkmcnt(0)
    buffer_load_dwordx4 v[88:91], v[100:101], s[76:79], 0 idxen offen sc1
    s_mov_b64 exec, s[36:37]
    ds_read2st64_b32 v[52:53], v102 offset0:16 offset1:152
    ds_read2st64_b32 v[54:55], v103 offset0:16 offset1:152
    ds_read_u16 v102, v105 offset:128
    ds_read_u16 v103, v105 offset:132
    s_mov_b64 exec, -1
    ds_read_u16 v98, v104 offset:224
    s_waitcnt vmcnt(4)
    v_pk_fma_f32 v[40:41], v[40:41], s[26:27], s[26:27] op_sel:[0,0,1] op_sel_hi:[1,0,1]
    v_pk_fma_f32 v[42:43], v[42:43], s[26:27], s[26:27] op_sel:[0,0,1] op_sel_hi:[1,0,1]
    v_pk_fma_f32 v[28:29], v[28:29], v[40:41], 1.0 op_sel_hi:[1,1,0]
    v_pk_fma_f32 v[30:31], v[30:31], v[42:43], 1.0 op_sel_hi:[1,1,0]
    v_pk_fma_f32 v[32:33], v[32:33], v[40:41], v[64:65]
    v_pk_fma_f32 v[34:35], v[34:35], v[42:43], v[66:67]
L_ep0:
    v_rcp_f32 v28, v28
    v_rcp_f32 v29, v29
    v_rcp_f32 v30, v30
    v_rcp_f32 v31, v31
    s_cmp_ge_u32 s22, 4
    s_cbranch_scc1 L_bx0
    s_waitcnt vmcnt(1)
L_bx0:
    v_pk_fma_f32 v[32:33], v[32:33], v[28:29], v[56:57]
    v_pk_fma_f32 v[34:35], v[34:35], v[30:31], v[58:59]
    ds_read_b128 v[56:59], v108
    v_max_f32 v32, 0, v32
    v_max_f32 v33, 0, v33
    v_max_f32 v34, 0, v34
    v_max_f32 v35, 0, v35
    v_lshrrev_b64 v[106:107], 16, v[106:107]
    v_mov_b64 v[28:29], s[28:29]
    v_mfma_f32_4x4x4_16b_bf16 v[20:23], v[120:121], v[96:97], v[32:35]
    v_mov_b64 v[30:31], s[28:29]
    v_mad_u32_u16 v108, v106, 16, v122 op_sel:[1,0,0,0]
    v_mov_b64 v[32:33], 0
    v_mov_b64 v[34:35], 0
    ds_read_b128 v[60:63], v108
    v_cvt_pk_bf16_f32 v20, v20, v21
    v_cvt_pk_bf16_f32 v21, v22, v23
    s_mov_b32 s30, s31
    s_mov_b32 s22, s31
    s_mov_b32 s31, s32
    s_mov_b32 s32, s33
    s_mov_b32 s33, 0
    buffer_store_dwordx2 v[20:21], v109, s[60:63], 0 offen sc1
L_ns0:
    v_mad_u32_u16 v109, v106, s35, v123
    s_sub_u32 s24, s30, 2
    s_cbranch_scc1 L_fin
    buffer_load_dwordx2 v[96:97], v109, s[40:43], 0 offen
    s_cmp_lg_u32 s32, 0
    s_cbranch_scc1 L_pt0
    s_setprio 2
    s_cmp_lg_u32 s31, 0
    s_cbranch_scc1 L_pt0
    s_setprio 1
L_pt0:
    v_mov_b32 v12, 0x51000000
    v_mov_b32 v13, v12
    v_mov_b64 v[14:15], v[12:13]
    v_mov_b64 v[64:65], 0
    v_mov_b64 v[66:67], 0
    v_mfma_f32_16x16x32_bf16 v[40:43], v[48:51], v[112:115], v[36:39]
    v_exp_f32 v44, v44 clamp
    v_mfma_f32_16x16x32_bf16 v[40:43], v[116:119], v[72:75], v[40:43]
    v_exp_f32 v45, v45 clamp
    v_exp_f32 v46, v46 clamp
    v_exp_f32 v47, v47 clamp
    s_branch L_m0_1
L_slow:
    s_waitcnt vmcnt(0) lgkmcnt(0)
    s_barrier
    v_mov_b64 v[4:5], 0
    v_mov_b64 v[6:7], 0
    v_lshlrev_b32 v2, 4, v0
    v_add_u32 v2, 4096, v2
    s_mov_b32 s18, 0
L_sz:
    v_cmp_gt_u32 vcc, 104448, v2
    s_mov_b64 exec, vcc
    ds_write_b128 v2, v[4:7]
    s_mov_b64 exec, -1
    v_add_u32 v2, 16384, v2
    s_add_u32 s18, s18, 1
    s_cmp_lt_u32 s18, 7
    s_cbranch_scc1 L_sz
    s_cmp_gt_u32 s3, 1
    s_cbranch_scc1 L_swc
    v_lshrrev_b32 v3, 4, v0
    v_bfe_u32 v4, v0, 2, 2
    v_and_b32 v5, 3, v0
    v_lshl_add_u32 v3, v3, 2, v5
    v_lshlrev_b32 v3, 1, v3
    v_lshl_add_u32 v3, v4, 8, v3
    s_lshl_b32 s20, s4, 6
    buffer_load_ushort v3, v3, s[80:83], s20 offen
    v_lshlrev_b32 v4, 2, v0
    v_add_u32 v4, 104448, v4
    s_waitcnt vmcnt(0)
    v_lshlrev_b32 v3, 16, v3
    v_mul_f32 v3, 0xbfb8aa3b, v3
    ds_write_b32 v4, v3
L_swc:
    s_cmp_lg_u32 s3, 12
    s_cbranch_scc1 L_ni2b
    v_lshlrev_b32 v20, 3, v1
    s_lshl_b32 s12, s4, 9
    s_add_u32 s12, s12, 7340032
    buffer_load_dwordx2 v[22:23], v20, s[68:71], s12 offen sc1
    v_mov_b32 v18, 808
    ds_read_b64 v[18:19], v18
    s_mov_b32 s13, 0x40000
L_ni2b:
    s_cmp_lg_u32 s3, 12
    s_cbranch_scc1 L_np2b
    v_lshlrev_b32 v20, 3, v1
    s_waitcnt vmcnt(0) lgkmcnt(0)
L_poll2b:
    v_cmpx_ne_u64 vcc, v[18:19], v[22:23]
    s_sub_u32 s13, s13, 1
    s_cbranch_scc1 L_poll2db
    s_cbranch_vccz L_poll2db
    s_sleep 1
    buffer_load_dwordx2 v[22:23], v20, s[68:71], s12 offen sc1
    s_waitcnt vmcnt(0)
    s_branch L_poll2b
L_poll2db:
    s_mov_b64 exec, -1
L_np2b:
    s_waitcnt vmcnt(0) lgkmcnt(0)
    s_barrier
    s_mul_i32 s20, s5, 392
    s_mov_b32 s21, 400000
    s_movk_i32 s22, 392
    v_mov_b32 v2, v0
    s_mov_b32 s18, 0
L_se:
    v_lshlrev_b32 v3, 2, v2
    v_lshlrev_b32 v4, 3, v2
    buffer_load_dword v5, v3, s[52:55], 0 offen
    v_cmp_gt_u32 s[24:25], s21, v2
    s_waitcnt vmcnt(0)
    v_subrev_u32 v5, s20, v5
    v_cmp_gt_u32 vcc, s22, v5
    s_and_b64 exec, vcc, s[24:25]
    s_cbranch_execz L_sn
    buffer_load_dword v6, v3, s[48:51], 0 offen
    buffer_load_dwordx2 v[8:9], v4, s[44:47], 0 offen
    v_lshlrev_b32 v7, 4, v5
    v_add_u32 v7, 113536, v7
    v_lshlrev_b32 v14, 8, v5
    v_add_u32 v14, 4096, v14
    v_mov_b32 v15, 104448
    s_mov_b32 s19, 0
    s_waitcnt vmcnt(0)
    v_lshlrev_b32 v6, 7, v6
    v_lshlrev_b32 v10, 16, v8
    v_and_b32 v11, 0xffff0000, v8
    v_lshlrev_b32 v12, 16, v9
    v_and_b32 v13, 0xffff0000, v9
L_sc:
    buffer_load_dwordx4 v[16:19], v6, s[72:75], s19 offen sc1
    ds_read_b128 v[20:23], v7
    ds_read_b128 v[24:27], v15
    ds_read_b128 v[28:31], v15 offset:16
    ds_read_b128 v[32:35], v15 offset:32
    ds_read_b128 v[36:39], v15 offset:48
    s_waitcnt vmcnt(0) lgkmcnt(0)
    v_lshlrev_b32 v40, 16, v16
    v_lshlrev_b32 v41, 16, v20
    v_add_f32 v40, v40, v41
    v_fmac_f32 v40, v10, v24
    v_fmac_f32 v40, v11, v28
    v_fmac_f32 v40, v12, v32
    v_fmac_f32 v40, v13, v36
    v_exp_f32 v40, v40
    s_nop 0
    v_add_f32 v40, 1.0, v40
    v_rcp_f32 v40, v40
    s_nop 0
    v_mul_f32 v41, v40, v16
    ds_add_f32 v14, v40 offset:0
    ds_add_f32 v14, v41 offset:128
    v_lshlrev_b32 v40, 16, v17
    v_lshlrev_b32 v41, 16, v21
    v_add_f32 v40, v40, v41
    v_fmac_f32 v40, v10, v25
    v_fmac_f32 v40, v11, v29
    v_fmac_f32 v40, v12, v33
    v_fmac_f32 v40, v13, v37
    v_exp_f32 v40, v40
    s_nop 0
    v_add_f32 v40, 1.0, v40
    v_rcp_f32 v40, v40
    s_nop 0
    v_mul_f32 v41, v40, v17
    ds_add_f32 v14, v40 offset:4
    ds_add_f32 v14, v41 offset:132
    v_lshlrev_b32 v40, 16, v18
    v_lshlrev_b32 v41, 16, v22
    v_add_f32 v40, v40, v41
    v_fmac_f32 v40, v10, v26
    v_fmac_f32 v40, v11, v30
    v_fmac_f32 v40, v12, v34
    v_fmac_f32 v40, v13, v38
    v_exp_f32 v40, v40
    s_nop 0
    v_add_f32 v40, 1.0, v40
    v_rcp_f32 v40, v40
    s_nop 0
    v_mul_f32 v41, v40, v18
    ds_add_f32 v14, v40 offset:8
    ds_add_f32 v14, v41 offset:136
    v_lshlrev_b32 v40, 16, v19
    v_lshlrev_b32 v41, 16, v23
    v_add_f32 v40, v40, v41
    v_fmac_f32 v40, v10, v27
    v_fmac_f32 v40, v11, v31
    v_fmac_f32 v40, v12, v35
    v_fmac_f32 v40, v13, v39
    v_exp_f32 v40, v40
    s_nop 0
    v_add_f32 v40, 1.0, v40
    v_rcp_f32 v40, v40
    s_nop 0
    v_mul_f32 v41, v40, v19
    ds_add_f32 v14, v40 offset:12
    ds_add_f32 v14, v41 offset:140
    v_add_u32 v7, 6288, v7
    v_add_u32 v14, 16, v14
    v_add_u32 v15, 64, v15
    s_add_u32 s19, s19, 16
    s_cmp_lt_u32 s19, 128
    s_cbranch_scc1 L_sc
L_sn:
    s_mov_b64 exec, -1
    v_add_u32 v2, 1024, v2
    s_add_u32 s18, s18, 1
    s_cmp_lt_u32 s18, 391
    s_cbranch_scc1 L_se
    s_waitcnt lgkmcnt(0)
    s_barrier
    s_mul_i32 s20, s5, 100352
    s_lshl_b32 s19, s4, 6
    s_add_u32 s20, s20, s19
    v_mov_b32 v2, v0
    s_mov_b32 s18, 0
L_so:
    v_cmp_gt_u32 vcc, 3136, v2
    s_mov_b64 exec, vcc
    s_cbranch_execz L_fin
    v_lshrrev_b32 v3, 3, v2
    v_and_b32 v4, 7, v2
    v_lshlrev_b32 v5, 8, v3
    v_lshl_add_u32 v6, v4, 3, v5
    buffer_load_dwordx2 v[8:9], v6, s[40:43], s20 offen
    v_lshl_add_u32 v5, v4, 4, v5
    v_add_u32 v5, 4096, v5
    ds_read_b128 v[16:19], v5
    ds_read_b128 v[20:23], v5 offset:128
    v_mul_u32_u24 v7, 6288, v4
    v_lshl_add_u32 v7, v3, 4, v7
    v_add_u32 v7, 113536, v7
    ds_read_b128 v[24:27], v7
    s_waitcnt vmcnt(0) lgkmcnt(0)
    v_lshlrev_b32 v10, 16, v8
    v_and_b32 v11, 0xffff0000, v8
    v_lshlrev_b32 v12, 16, v9
    v_and_b32 v13, 0xffff0000, v9
    v_add_f32 v16, 0x358637bd, v16
    v_rcp_f32 v16, v16
    s_nop 0
    v_fmac_f32 v24, v16, v20
    v_max_f32 v24, 0, v24
    v_add_f32 v24, v24, v10
    v_add_f32 v17, 0x358637bd, v17
    v_rcp_f32 v17, v17
    s_nop 0
    v_fmac_f32 v25, v17, v21
    v_max_f32 v25, 0, v25
    v_add_f32 v25, v25, v11
    v_add_f32 v18, 0x358637bd, v18
    v_rcp_f32 v18, v18
    s_nop 0
    v_fmac_f32 v26, v18, v22
    v_max_f32 v26, 0, v26
    v_add_f32 v26, v26, v12
    v_add_f32 v19, 0x358637bd, v19
    v_rcp_f32 v19, v19
    s_nop 0
    v_fmac_f32 v27, v19, v23
    v_max_f32 v27, 0, v27
    v_add_f32 v27, v27, v13
    v_cvt_pk_bf16_f32 v8, v24, v25
    v_cvt_pk_bf16_f32 v9, v26, v27
    buffer_store_dwordx2 v[8:9], v6, s[60:63], s20 offen
    v_add_u32 v2, 1024, v2
    s_add_u32 s18, s18, 1
    s_cmp_lt_u32 s18, 4
    s_cbranch_scc1 L_so
L_fin:
L_end:
    s_endpgm
.section .rodata,"a"
.p2align 6
.amdhsa_kernel standalone__edge_featured_mpnn_gatedgcn__graph_kernel
  .amdhsa_next_free_vgpr 128
  .amdhsa_next_free_sgpr 102
  .amdhsa_accum_offset 128
  .amdhsa_group_segment_fixed_size 0
  .amdhsa_kernarg_size 96
  .amdhsa_user_sgpr_count 2
  .amdhsa_user_sgpr_kernarg_segment_ptr 1
  .amdhsa_system_sgpr_workgroup_id_x 1
.end_amdhsa_kernel
```
